```python
import torch

def _softmax(x, axis=-1):
    return torch.softmax(x, dim=axis)
def _gelu(x):
    return torch.nn.functional.gelu(x, approximate="tanh")
def _silu(x):
    return torch.nn.functional.silu(x)
def _sigmoid(x):
    return torch.sigmoid(x)
def _layernorm(x, axis=-1, eps=1e-5):
    m = x.mean(dim=axis, keepdim=True)
    v = x.var(dim=axis, keepdim=True, unbiased=False)
    return (x - m) / torch.sqrt(v + eps)
def _scatter_add(tgt, idx, src, axis=0):
    return tgt.clone().index_add_(axis, idx, src)
def _segment_sum(src, seg, n):
    out = torch.zeros((n,) + src.shape[1:], dtype=src.dtype)
    return out.index_add_(0, seg, src)
def _pad(x, pw):
    flat = tuple(v for pair in reversed(pw) for v in pair)
    return torch.nn.functional.pad(x, flat)

kernel_name = 'standalone__paged_block_table_kv_pagedattention__sampling'

def setup_inputs():

    _w = (lambda a: (lambda t: t.to(torch.bfloat16) if t.is_floating_point() else t)(torch.as_tensor(a)))
    B, Hq, Hkv, Sq, Skv, D = 8, 32, 8, 32, 8192, 128
    bs = 16
    nbps = max(1, Skv // bs)
    num_phys = B * nbps + 4
    bt = torch.randperm(num_phys)[: B * nbps].reshape(B, nbps).to(torch.int64)
    cl = (nbps * bs - (torch.arange(1, B + 1, dtype=torch.int64) * 2654435761) % max(1, nbps * bs // 2)).to(torch.int64)
    return {
        "q": _w((lambda *s: torch.randn(*s, dtype=torch.bfloat16) * 0.8)(B, Hq, Sq, D)),
        "k_cache": _w((lambda *s: torch.randn(*s, dtype=torch.bfloat16) * 0.8)(num_phys, bs, Hkv, D)),
        "v_cache": _w((lambda *s: torch.randn(*s, dtype=torch.bfloat16) * 0.05)(num_phys, bs, Hkv, D)),
        "block_table": _w(bt),
        "context_lens": _w(cl),
    }

def reference(q, k_cache, v_cache, block_table, context_lens):
    B, Hq, Sq, D = q.shape
    bs = k_cache.shape[1]
    Hkv = k_cache.shape[2]
    nbps = block_table.shape[1]
    Skv = nbps * bs
    bt = block_table.reshape(-1)
    k = (lambda x, *d: x.permute(*d))(k_cache[bt].reshape(B, Skv, Hkv, D), 0, 2, 1, 3)
    v = (lambda x, *d: x.permute(*d))(v_cache[bt].reshape(B, Skv, Hkv, D), 0, 2, 1, 3)
    g = Hq // Hkv
    qg = q.reshape(B, Hkv, g, Sq, D)
    scores = torch.einsum("bhgqd,bhkd->bhgqk", qg, k) * (D ** -0.5)
    pos = torch.arange(Skv)
    msk = pos[None, :] < context_lens[:, None]
    scores = torch.where(msk[:, None, None, None, :], scores, -1e9)
    p = _softmax(scores, axis=-1)
    out = torch.einsum("bhgqk,bhkd->bhgqd", p, v)
    return out.reshape(B, Hq, Sq, D)
```

```asm
; @launch kernel=standalone__paged_block_table_kv_pagedattention__sampling_kernel grid=(256,1,1) block=(512,1,1) lds=163840
; @launch kernel=combine_kernel grid=(256,1,1) block=(512,1,1) lds=0
.amdgcn_target "amdgcn-amd-amdhsa--gfx950"
.text
.globl standalone__paged_block_table_kv_pagedattention__sampling_kernel
.p2align 8
.type standalone__paged_block_table_kv_pagedattention__sampling_kernel,@function
standalone__paged_block_table_kv_pagedattention__sampling_kernel:
    s_cmp_ge_u32 s2, 256
    s_cbranch_scc1 L_exit
    s_load_dwordx16 s[4:19], s[0:1], 0
    v_and_b32 v1, 63, v0
    v_lshrrev_b32 v24, 6, v0
    s_and_b32 s65, s2, 7
    s_lshr_b32 s66, s2, 3
    v_readfirstlane_b32 s69, v24
    v_lshlrev_b32 v25, 4, v1
    s_waitcnt lgkmcnt(0)
    s_load_dwordx8 s[40:47], s[12:13], 0
    s_mov_b32 s36, s10
    s_and_b32 s37, s11, 0xffff
    s_mov_b32 s38, 16384
    s_mov_b32 s39, 0x00020000
    s_lshl_b32 s88, s69, 11
    s_add_u32 m0, s88, 98304
    s_lshr_b32 s27, s69, 2
    buffer_load_dwordx4 v25, s[36:39], s88 offen offset:0 lds
    buffer_load_dwordx4 v25, s[36:39], s88 offen offset:1024 lds
    s_and_b32 s78, s69, 3
    s_cmp_eq_u32 s27, 0
    s_cselect_b32 s20, s6, s8
    s_cselect_b32 s21, s7, s9
    s_and_b32 s21, s21, 0xffff
    s_mov_b32 s23, 0x00020000
    s_mov_b32 s28, s4
    s_and_b32 s29, s5, 0xffff
    s_mov_b32 s30, 2097152
    s_mov_b32 s31, 0x00020000
    s_mov_b32 s32, s18
    s_and_b32 s33, s19, 0xffff
    s_mov_b32 s34, 10649664
    s_mov_b32 s35, 0x00020000
    s_lshl_b32 s88, s78, 12
    s_cmp_eq_u32 s27, 0
    s_mov_b32 s24, 0
    s_cselect_b32 s24, s24, 81920
    s_mov_b32 s25, 16384
    s_cselect_b32 s25, s25, 49152
    s_mov_b32 s26, 32768
    s_cselect_b32 s26, s26, 65536
    s_cselect_b32 s93, 3, 2
    s_cselect_b32 s89, 15, 0
    s_cselect_b32 s90, 0, 15
    s_add_u32 s24, s24, s88
    s_add_u32 s25, s25, s88
    s_add_u32 s26, s26, s88
    v_lshrrev_b32 v24, 4, v1
    v_and_b32 v25, 15, v1
    v_lshlrev_b32 v26, 1, v24
    v_and_b32 v26, s90, v26
    v_xor_b32 v26, v26, v25
    v_xor_b32 v29, v24, v25
    v_lshlrev_b32 v29, 4, v29
    v_lshl_add_u32 v29, v24, 8, v29
    s_cmp_eq_u32 s27, 0
    s_cselect_b32 s91, 0, 0
    v_and_b32 v27, s89, v24
    v_xor_b32 v27, v27, v26
    v_xor_b32 v27, s91, v27
    v_lshlrev_b32 v27, 4, v27
    v_lshl_add_u32 v27, v24, 11, v27
    v_add_u32 v4, 0, v27
    s_cmp_eq_u32 s27, 0
    s_cselect_b32 s91, 4, 8
    v_and_b32 v27, s89, v24
    v_xor_b32 v27, v27, v26
    v_xor_b32 v27, s91, v27
    v_lshlrev_b32 v27, 4, v27
    v_lshl_add_u32 v27, v24, 11, v27
    v_add_u32 v5, 7168, v27
    s_cmp_eq_u32 s27, 0
    s_cselect_b32 s91, 8, 0
    v_and_b32 v27, s89, v24
    v_xor_b32 v27, v27, v26
    v_xor_b32 v27, s91, v27
    v_lshlrev_b32 v27, 4, v27
    v_lshl_add_u32 v27, v24, 11, v27
    v_add_u32 v6, 14336, v27
    s_cmp_eq_u32 s27, 0
    s_cselect_b32 s91, 12, 8
    v_and_b32 v27, s89, v24
    v_xor_b32 v27, v27, v26
    v_xor_b32 v27, s91, v27
    v_lshlrev_b32 v27, 4, v27
    v_lshl_add_u32 v27, v24, 11, v27
    v_add_u32 v7, 21504, v27
    s_lshl_b32 s88, s27, 13
    v_xor_b32 v27, v24, v25
    v_lshl_add_u32 v27, v27, 4, s88
    v_lshl_add_u32 v27, v25, 8, v27
    v_xor_b32 v8, 0, v27
    v_xor_b32 v9, 64, v27
    v_xor_b32 v10, 128, v27
    v_xor_b32 v11, 192, v27
    s_lshl_b32 s89, s78, 13
    s_lshl_b32 s90, s27, 12
    s_add_u32 s89, s89, s90
    v_lshl_add_u32 v30, v1, 4, s89
    v_lshrrev_b32 v26, 2, v1
    v_and_b32 v28, 7, v26
    v_lshlrev_b32 v27, 8, v26
    v_lshl_add_u32 v27, v28, 5, v27
    v_and_b32 v28, 3, v1
    v_lshl_add_u32 v27, v28, 3, v27
    s_lshl_b32 s89, s27, 7
    v_xor_b32 v27, s89, v27
    s_add_u32 s88, s88, 49152
    v_add_u32 v27, s88, v27
    v_xor_b32 v12, 0, v27
    v_xor_b32 v13, 32, v27
    v_xor_b32 v14, 64, v27
    v_xor_b32 v15, 96, v27
    v_xor_b32 v16, 128, v27
    v_xor_b32 v17, 160, v27
    v_xor_b32 v18, 192, v27
    v_xor_b32 v19, 224, v27
    s_waitcnt lgkmcnt(0)
    s_cmp_lt_i32 s40, 1
    s_cselect_b32 s88, 0x2000, s40
    s_min_u32 s88, s88, 0x2000
    s_add_u32 s88, s88, 63
    s_lshr_b32 s48, s88, 6
    s_cmp_lt_i32 s41, 1
    s_cselect_b32 s88, 0x2000, s41
    s_min_u32 s88, s88, 0x2000
    s_add_u32 s88, s88, 63
    s_lshr_b32 s49, s88, 6
    s_cmp_lt_i32 s42, 1
    s_cselect_b32 s88, 0x2000, s42
    s_min_u32 s88, s88, 0x2000
    s_add_u32 s88, s88, 63
    s_lshr_b32 s50, s88, 6
    s_cmp_lt_i32 s43, 1
    s_cselect_b32 s88, 0x2000, s43
    s_min_u32 s88, s88, 0x2000
    s_add_u32 s88, s88, 63
    s_lshr_b32 s51, s88, 6
    s_cmp_lt_i32 s44, 1
    s_cselect_b32 s88, 0x2000, s44
    s_min_u32 s88, s88, 0x2000
    s_add_u32 s88, s88, 63
    s_lshr_b32 s52, s88, 6
    s_cmp_lt_i32 s45, 1
    s_cselect_b32 s88, 0x2000, s45
    s_min_u32 s88, s88, 0x2000
    s_add_u32 s88, s88, 63
    s_lshr_b32 s53, s88, 6
    s_cmp_lt_i32 s46, 1
    s_cselect_b32 s88, 0x2000, s46
    s_min_u32 s88, s88, 0x2000
    s_add_u32 s88, s88, 63
    s_lshr_b32 s54, s88, 6
    s_cmp_lt_i32 s47, 1
    s_cselect_b32 s88, 0x2000, s47
    s_min_u32 s88, s88, 0x2000
    s_add_u32 s88, s88, 63
    s_lshr_b32 s55, s88, 6
    s_mov_b32 s56, 0
    s_add_u32 s57, s56, s48
    s_add_u32 s58, s57, s49
    s_add_u32 s59, s58, s50
    s_add_u32 s60, s59, s51
    s_add_u32 s61, s60, s52
    s_add_u32 s62, s61, s53
    s_add_u32 s63, s62, s54
    s_add_u32 s64, s63, s55
    s_add_u32 s88, s64, 14
    v_mul_u32_u24 v33, s88, v1
    v_lshrrev_b32 v33, 5, v33
    v_mov_b32 v32, v33
    s_add_u32 s88, s57, 0
    v_subrev_u32 v34, s88, v33
    v_med3_i32 v34, v34, 0, 2
    v_sub_u32 v32, v32, v34
    s_add_u32 s88, s58, 2
    v_subrev_u32 v34, s88, v33
    v_med3_i32 v34, v34, 0, 2
    v_sub_u32 v32, v32, v34
    s_add_u32 s88, s59, 4
    v_subrev_u32 v34, s88, v33
    v_med3_i32 v34, v34, 0, 2
    v_sub_u32 v32, v32, v34
    s_add_u32 s88, s60, 6
    v_subrev_u32 v34, s88, v33
    v_med3_i32 v34, v34, 0, 2
    v_sub_u32 v32, v32, v34
    s_add_u32 s88, s61, 8
    v_subrev_u32 v34, s88, v33
    v_med3_i32 v34, v34, 0, 2
    v_sub_u32 v32, v32, v34
    s_add_u32 s88, s62, 10
    v_subrev_u32 v34, s88, v33
    v_med3_i32 v34, v34, 0, 2
    v_sub_u32 v32, v32, v34
    s_add_u32 s88, s63, 12
    v_subrev_u32 v34, s88, v33
    v_med3_i32 v34, v34, 0, 2
    v_sub_u32 v32, v32, v34
    s_add_u32 s88, s66, 1
    v_readlane_b32 s67, v32, s66
    v_readlane_b32 s68, v32, s88
    s_nop 2
    s_sub_u32 s76, s68, s67
    s_cmp_eq_u32 s76, 0
    s_cbranch_scc1 L_empty
    s_mov_b32 s70, 0
    s_mov_b32 s71, 0
    s_cmp_le_u32 s57, s67
    s_cselect_b32 s70, 1, s70
    s_cselect_b32 s71, s57, s71
    s_cmp_le_u32 s58, s67
    s_cselect_b32 s70, 2, s70
    s_cselect_b32 s71, s58, s71
    s_cmp_le_u32 s59, s67
    s_cselect_b32 s70, 3, s70
    s_cselect_b32 s71, s59, s71
    s_cmp_le_u32 s60, s67
    s_cselect_b32 s70, 4, s70
    s_cselect_b32 s71, s60, s71
    s_cmp_le_u32 s61, s67
    s_cselect_b32 s70, 5, s70
    s_cselect_b32 s71, s61, s71
    s_cmp_le_u32 s62, s67
    s_cselect_b32 s70, 6, s70
    s_cselect_b32 s71, s62, s71
    s_cmp_le_u32 s63, s67
    s_cselect_b32 s70, 7, s70
    s_cselect_b32 s71, s63, s71
    s_lshl_b32 s88, s70, 3
    s_add_u32 s88, s88, s65
    s_lshl_b32 s88, s88, 3
    s_add_u32 s88, s88, s69
    s_lshl_b32 s88, s88, 12
    s_lshl_b32 s89, s69, 12
    s_add_u32 m0, s89, 131072
    v_xor_b32 v161, 64, v29
    v_xor_b32 v162, 128, v29
    v_xor_b32 v163, 192, v29
    buffer_load_dwordx4 v29, s[28:31], s88 offen offset:0 lds
    buffer_load_dwordx4 v161, s[28:31], s88 offen offset:1024 lds
    buffer_load_dwordx4 v162, s[28:31], s88 offen offset:2048 lds
    buffer_load_dwordx4 v163, s[28:31], s88 offen offset:3072 lds
    v_add_u32 v24, s67, v1
    s_sub_u32 s88, s68, 1
    v_min_u32 v24, s88, v24
    v_lshl_add_u32 v25, v24, 2, s78
    s_lshl_b32 s88, s48, 2
    s_sub_u32 s88, 512, s88
    v_cmp_le_u32 vcc, s57, v24
    v_mov_b32 v26, s88
    v_writelane_b32 v3, s40, 0
    v_cndmask_b32 v26, 0, v26, vcc
    v_add_u32 v25, v25, v26
    s_lshl_b32 s88, s49, 2
    s_sub_u32 s88, 512, s88
    v_cmp_le_u32 vcc, s58, v24
    v_mov_b32 v26, s88
    v_writelane_b32 v3, s41, 1
    v_cndmask_b32 v26, 0, v26, vcc
    v_add_u32 v25, v25, v26
    s_lshl_b32 s88, s50, 2
    s_sub_u32 s88, 512, s88
    v_cmp_le_u32 vcc, s59, v24
    v_mov_b32 v26, s88
    v_writelane_b32 v3, s42, 2
    v_cndmask_b32 v26, 0, v26, vcc
    v_add_u32 v25, v25, v26
    s_lshl_b32 s88, s51, 2
    s_sub_u32 s88, 512, s88
    v_cmp_le_u32 vcc, s60, v24
    v_mov_b32 v26, s88
    v_writelane_b32 v3, s43, 3
    v_cndmask_b32 v26, 0, v26, vcc
    v_add_u32 v25, v25, v26
    s_lshl_b32 s88, s52, 2
    s_sub_u32 s88, 512, s88
    v_cmp_le_u32 vcc, s61, v24
    v_mov_b32 v26, s88
    v_writelane_b32 v3, s44, 4
    v_cndmask_b32 v26, 0, v26, vcc
    v_add_u32 v25, v25, v26
    s_lshl_b32 s88, s53, 2
    s_sub_u32 s88, 512, s88
    v_cmp_le_u32 vcc, s62, v24
    v_mov_b32 v26, s88
    v_writelane_b32 v3, s45, 5
    v_cndmask_b32 v26, 0, v26, vcc
    v_add_u32 v25, v25, v26
    s_lshl_b32 s88, s54, 2
    s_sub_u32 s88, 512, s88
    v_cmp_le_u32 vcc, s63, v24
    v_mov_b32 v26, s88
    v_writelane_b32 v3, s46, 6
    v_cndmask_b32 v26, 0, v26, vcc
    v_add_u32 v25, v25, v26
    v_writelane_b32 v3, s47, 7
    v_lshlrev_b32 v25, 2, v25
    s_waitcnt vmcnt(4)
    s_barrier
    v_add_u32 v25, 98304, v25
    ds_read_b32 v2, v25
    s_lshl_b32 s91, s65, 8
    s_waitcnt lgkmcnt(0)
    v_lshl_add_u32 v2, v2, 15, s91
    s_cmp_lg_u32 s27, 0
    s_cbranch_scc1 L_fillv
    v_readlane_b32 s79, v2, 0
    s_cmp_gt_u32 s76, 0
    s_cselect_b32 s22, 134348800, 0
    s_add_u32 m0, s24, 0
    s_nop 1
    buffer_load_dwordx4 v4, s[20:23], s79 offen offset:0 nt lds
    buffer_load_dwordx4 v5, s[20:23], s79 offen offset:1024 nt lds
    buffer_load_dwordx4 v6, s[20:23], s79 offen offset:2048 nt lds
    buffer_load_dwordx4 v7, s[20:23], s79 offen offset:3072 nt lds
    v_readlane_b32 s79, v2, 1
    s_cmp_gt_u32 s76, 1
    s_cselect_b32 s22, 134348800, 0
    s_add_u32 m0, s24, 16384
    s_nop 1
    buffer_load_dwordx4 v4, s[20:23], s79 offen offset:0 nt lds
    buffer_load_dwordx4 v5, s[20:23], s79 offen offset:1024 nt lds
    buffer_load_dwordx4 v6, s[20:23], s79 offen offset:2048 nt lds
    buffer_load_dwordx4 v7, s[20:23], s79 offen offset:3072 nt lds
    v_readlane_b32 s79, v2, 2
    s_cmp_gt_u32 s76, 2
    s_cselect_b32 s22, 134348800, 0
    s_add_u32 m0, s24, 32768
    s_nop 1
    buffer_load_dwordx4 v4, s[20:23], s79 offen offset:0 nt lds
    buffer_load_dwordx4 v5, s[20:23], s79 offen offset:1024 nt lds
    buffer_load_dwordx4 v6, s[20:23], s79 offen offset:2048 nt lds
    buffer_load_dwordx4 v7, s[20:23], s79 offen offset:3072 nt lds
    v_mov_b32 v72, 0
    v_mov_b32 v73, 0
    v_mov_b32 v74, 0
    v_mov_b32 v75, 0
    v_mov_b32 v76, 0
    v_mov_b32 v77, 0
    v_mov_b32 v78, 0
    v_mov_b32 v79, 0
    v_mov_b32 v80, 0
    v_mov_b32 v81, 0
    v_mov_b32 v82, 0
    v_mov_b32 v83, 0
    v_mov_b32 v84, 0
    v_mov_b32 v85, 0
    v_mov_b32 v86, 0
    v_mov_b32 v87, 0
    v_mov_b32 v88, 0
    v_mov_b32 v89, 0
    v_mov_b32 v90, 0
    v_mov_b32 v91, 0
    v_mov_b32 v92, 0
    v_mov_b32 v93, 0
    v_mov_b32 v94, 0
    v_mov_b32 v95, 0
    v_mov_b32 v96, 0
    v_mov_b32 v97, 0
    v_mov_b32 v98, 0
    v_mov_b32 v99, 0
    v_mov_b32 v100, 0
    v_mov_b32 v101, 0
    v_mov_b32 v102, 0
    v_mov_b32 v103, 0
    v_mov_b32 v104, 0
    v_mov_b32 v105, 0
    v_mov_b32 v106, 0
    v_mov_b32 v107, 0
    v_mov_b32 v108, 0
    v_mov_b32 v109, 0
    v_mov_b32 v110, 0
    v_mov_b32 v111, 0
    v_mov_b32 v112, 0
    v_mov_b32 v113, 0
    v_mov_b32 v114, 0
    v_mov_b32 v115, 0
    v_mov_b32 v116, 0
    v_mov_b32 v117, 0
    v_mov_b32 v118, 0
    v_mov_b32 v119, 0
    v_mov_b32 v120, 0
    v_mov_b32 v121, 0
    v_mov_b32 v122, 0
    v_mov_b32 v123, 0
    v_mov_b32 v124, 0
    v_mov_b32 v125, 0
    v_mov_b32 v126, 0
    v_mov_b32 v127, 0
    v_mov_b32 v128, 0
    v_mov_b32 v129, 0
    v_mov_b32 v130, 0
    v_mov_b32 v131, 0
    v_mov_b32 v132, 0
    v_mov_b32 v133, 0
    v_mov_b32 v134, 0
    v_mov_b32 v135, 0
    v_mov_b32 v21, 0
    v_mov_b32 v22, 0
    s_waitcnt vmcnt(12)
    s_branch L_filled
L_fillv:
    v_readlane_b32 s79, v2, 0
    s_cmp_gt_u32 s76, 0
    s_cselect_b32 s22, 134348800, 0
    s_add_u32 m0, s25, 0
    s_nop 1
    buffer_load_dwordx4 v4, s[20:23], s79 offen offset:0 nt lds
    buffer_load_dwordx4 v5, s[20:23], s79 offen offset:1024 nt lds
    buffer_load_dwordx4 v6, s[20:23], s79 offen offset:2048 nt lds
    buffer_load_dwordx4 v7, s[20:23], s79 offen offset:3072 nt lds
    v_readlane_b32 s79, v2, 1
    s_cmp_gt_u32 s76, 1
    s_cselect_b32 s22, 134348800, 0
    s_add_u32 m0, s25, 16384
    s_nop 1
    buffer_load_dwordx4 v4, s[20:23], s79 offen offset:0 nt lds
    buffer_load_dwordx4 v5, s[20:23], s79 offen offset:1024 nt lds
    buffer_load_dwordx4 v6, s[20:23], s79 offen offset:2048 nt lds
    buffer_load_dwordx4 v7, s[20:23], s79 offen offset:3072 nt lds
    v_mov_b32 v72, 0
    v_mov_b32 v73, 0
    v_mov_b32 v74, 0
    v_mov_b32 v75, 0
    v_mov_b32 v76, 0
    v_mov_b32 v77, 0
    v_mov_b32 v78, 0
    v_mov_b32 v79, 0
    v_mov_b32 v80, 0
    v_mov_b32 v81, 0
    v_mov_b32 v82, 0
    v_mov_b32 v83, 0
    v_mov_b32 v84, 0
    v_mov_b32 v85, 0
    v_mov_b32 v86, 0
    v_mov_b32 v87, 0
    v_mov_b32 v88, 0
    v_mov_b32 v89, 0
    v_mov_b32 v90, 0
    v_mov_b32 v91, 0
    v_mov_b32 v92, 0
    v_mov_b32 v93, 0
    v_mov_b32 v94, 0
    v_mov_b32 v95, 0
    v_mov_b32 v96, 0
    v_mov_b32 v97, 0
    v_mov_b32 v98, 0
    v_mov_b32 v99, 0
    v_mov_b32 v100, 0
    v_mov_b32 v101, 0
    v_mov_b32 v102, 0
    v_mov_b32 v103, 0
    v_mov_b32 v104, 0
    v_mov_b32 v105, 0
    v_mov_b32 v106, 0
    v_mov_b32 v107, 0
    v_mov_b32 v108, 0
    v_mov_b32 v109, 0
    v_mov_b32 v110, 0
    v_mov_b32 v111, 0
    v_mov_b32 v112, 0
    v_mov_b32 v113, 0
    v_mov_b32 v114, 0
    v_mov_b32 v115, 0
    v_mov_b32 v116, 0
    v_mov_b32 v117, 0
    v_mov_b32 v118, 0
    v_mov_b32 v119, 0
    v_mov_b32 v120, 0
    v_mov_b32 v121, 0
    v_mov_b32 v122, 0
    v_mov_b32 v123, 0
    v_mov_b32 v124, 0
    v_mov_b32 v125, 0
    v_mov_b32 v126, 0
    v_mov_b32 v127, 0
    v_mov_b32 v128, 0
    v_mov_b32 v129, 0
    v_mov_b32 v130, 0
    v_mov_b32 v131, 0
    v_mov_b32 v132, 0
    v_mov_b32 v133, 0
    v_mov_b32 v134, 0
    v_mov_b32 v135, 0
    v_mov_b32 v21, 0
    v_mov_b32 v22, 0
    s_waitcnt vmcnt(8)
L_filled:
    s_lshl_b32 s88, s2, 3
    s_add_u32 s88, s88, s69
    s_cmp_lg_u32 s88, 7
    s_cbranch_scc1 L_nomask
    v_mov_b32 v33, v32
    v_lshlrev_b32 v34, 2, v1
    v_add_u32 v35, 4, v34
    ds_bpermute_b32 v33, v35, v32
    s_waitcnt lgkmcnt(0)
    v_max_u32 v36, s56, v32
    v_min_u32 v37, s57, v33
    v_cmp_lt_u32 vcc, v36, v37
    s_nop 3
    v_writelane_b32 v35, vcc_lo, 0
    v_max_u32 v36, s57, v32
    v_min_u32 v37, s58, v33
    v_cmp_lt_u32 vcc, v36, v37
    s_nop 3
    v_writelane_b32 v35, vcc_lo, 1
    v_max_u32 v36, s58, v32
    v_min_u32 v37, s59, v33
    v_cmp_lt_u32 vcc, v36, v37
    s_nop 3
    v_writelane_b32 v35, vcc_lo, 2
    v_max_u32 v36, s59, v32
    v_min_u32 v37, s60, v33
    v_cmp_lt_u32 vcc, v36, v37
    s_nop 3
    v_writelane_b32 v35, vcc_lo, 3
    v_max_u32 v36, s60, v32
    v_min_u32 v37, s61, v33
    v_cmp_lt_u32 vcc, v36, v37
    s_nop 3
    v_writelane_b32 v35, vcc_lo, 4
    v_max_u32 v36, s61, v32
    v_min_u32 v37, s62, v33
    v_cmp_lt_u32 vcc, v36, v37
    s_nop 3
    v_writelane_b32 v35, vcc_lo, 5
    v_max_u32 v36, s62, v32
    v_min_u32 v37, s63, v33
    v_cmp_lt_u32 vcc, v36, v37
    s_nop 3
    v_writelane_b32 v35, vcc_lo, 6
    v_max_u32 v36, s63, v32
    v_min_u32 v37, s64, v33
    v_cmp_lt_u32 vcc, v36, v37
    s_nop 3
    v_writelane_b32 v35, vcc_lo, 7
    s_mov_b32 s88, 10649600
    s_mov_b64 exec, 0xff
    buffer_store_dword v35, v34, s[32:35], s88 offen
    s_mov_b64 exec, -1
L_nomask:
    s_barrier
    s_sub_u32 s88, s78, s27
    s_lshl_b32 s88, s88, 13
    s_add_u32 s88, s88, 131072
    v_add_u32 v164, s88, v8
    v_add_u32 v165, s88, v9
    v_add_u32 v166, s88, v10
    v_add_u32 v167, s88, v11
    ds_read_b128 v[176:179], v164 offset:0
    ds_read_b128 v[180:183], v165 offset:0
    ds_read_b128 v[184:187], v166 offset:0
    ds_read_b128 v[188:191], v167 offset:0
    ds_read_b128 v[192:195], v164 offset:4096
    ds_read_b128 v[196:199], v165 offset:4096
    ds_read_b128 v[200:203], v166 offset:4096
    ds_read_b128 v[204:207], v167 offset:4096
    v_readlane_b32 s88, v3, s70
    s_nop 3
    s_cmp_lt_i32 s88, 1
    s_cselect_b32 s73, 0, 0x3e0293ee
    s_cselect_b32 s88, 0x2000, s88
    s_min_u32 s72, s88, 0x2000
    s_add_u32 s88, s72, 63
    s_lshr_b32 s88, s88, 6
    s_add_u32 s71, s71, s88
    s_sub_u32 s88, s71, 1
    s_and_b32 s89, s72, 63
    s_cselect_b32 s96, s88, -1
    s_min_u32 s87, s71, s68
    s_mov_b32 s75, 0
    s_mov_b32 s85, 1
    s_mov_b32 s84, 0
    s_mov_b32 s92, 0x41000000
    v_mov_b32 v160, s73
    v_mov_b32 v161, s73
    s_waitcnt lgkmcnt(7)
    v_lshlrev_b32 v168, 16, v176
    v_and_b32 v169, 0xffff0000, v176
    v_lshlrev_b32 v170, 16, v177
    v_and_b32 v171, 0xffff0000, v177
    v_lshlrev_b32 v172, 16, v178
    v_and_b32 v173, 0xffff0000, v178
    v_lshlrev_b32 v174, 16, v179
    v_and_b32 v175, 0xffff0000, v179
    v_pk_mul_f32 v[168:169], v[168:169], v[160:161]
    v_pk_mul_f32 v[170:171], v[170:171], v[160:161]
    v_pk_mul_f32 v[172:173], v[172:173], v[160:161]
    v_pk_mul_f32 v[174:175], v[174:175], v[160:161]
    v_cvt_pk_bf16_f32 v176, v168, v169
    v_cvt_pk_bf16_f32 v177, v170, v171
    v_cvt_pk_bf16_f32 v178, v172, v173
    v_cvt_pk_bf16_f32 v179, v174, v175
    s_waitcnt lgkmcnt(6)
    v_lshlrev_b32 v168, 16, v180
    v_and_b32 v169, 0xffff0000, v180
    v_lshlrev_b32 v170, 16, v181
    v_and_b32 v171, 0xffff0000, v181
    v_lshlrev_b32 v172, 16, v182
    v_and_b32 v173, 0xffff0000, v182
    v_lshlrev_b32 v174, 16, v183
    v_and_b32 v175, 0xffff0000, v183
    v_pk_mul_f32 v[168:169], v[168:169], v[160:161]
    v_pk_mul_f32 v[170:171], v[170:171], v[160:161]
    v_pk_mul_f32 v[172:173], v[172:173], v[160:161]
    v_pk_mul_f32 v[174:175], v[174:175], v[160:161]
    v_cvt_pk_bf16_f32 v180, v168, v169
    v_cvt_pk_bf16_f32 v181, v170, v171
    v_cvt_pk_bf16_f32 v182, v172, v173
    v_cvt_pk_bf16_f32 v183, v174, v175
    s_waitcnt lgkmcnt(5)
    v_lshlrev_b32 v168, 16, v184
    v_and_b32 v169, 0xffff0000, v184
    v_lshlrev_b32 v170, 16, v185
    v_and_b32 v171, 0xffff0000, v185
    v_lshlrev_b32 v172, 16, v186
    v_and_b32 v173, 0xffff0000, v186
    v_lshlrev_b32 v174, 16, v187
    v_and_b32 v175, 0xffff0000, v187
    v_pk_mul_f32 v[168:169], v[168:169], v[160:161]
    v_pk_mul_f32 v[170:171], v[170:171], v[160:161]
    v_pk_mul_f32 v[172:173], v[172:173], v[160:161]
    v_pk_mul_f32 v[174:175], v[174:175], v[160:161]
    v_cvt_pk_bf16_f32 v184, v168, v169
    v_cvt_pk_bf16_f32 v185, v170, v171
    v_cvt_pk_bf16_f32 v186, v172, v173
    v_cvt_pk_bf16_f32 v187, v174, v175
    s_waitcnt lgkmcnt(4)
    v_lshlrev_b32 v168, 16, v188
    v_and_b32 v169, 0xffff0000, v188
    v_lshlrev_b32 v170, 16, v189
    v_and_b32 v171, 0xffff0000, v189
    v_lshlrev_b32 v172, 16, v190
    v_and_b32 v173, 0xffff0000, v190
    v_lshlrev_b32 v174, 16, v191
    v_and_b32 v175, 0xffff0000, v191
    v_pk_mul_f32 v[168:169], v[168:169], v[160:161]
    v_pk_mul_f32 v[170:171], v[170:171], v[160:161]
    v_pk_mul_f32 v[172:173], v[172:173], v[160:161]
    v_pk_mul_f32 v[174:175], v[174:175], v[160:161]
    v_cvt_pk_bf16_f32 v188, v168, v169
    v_cvt_pk_bf16_f32 v189, v170, v171
    v_cvt_pk_bf16_f32 v190, v172, v173
    v_cvt_pk_bf16_f32 v191, v174, v175
    s_waitcnt lgkmcnt(3)
    v_lshlrev_b32 v168, 16, v192
    v_and_b32 v169, 0xffff0000, v192
    v_lshlrev_b32 v170, 16, v193
    v_and_b32 v171, 0xffff0000, v193
    v_lshlrev_b32 v172, 16, v194
    v_and_b32 v173, 0xffff0000, v194
    v_lshlrev_b32 v174, 16, v195
    v_and_b32 v175, 0xffff0000, v195
    v_pk_mul_f32 v[168:169], v[168:169], v[160:161]
    v_pk_mul_f32 v[170:171], v[170:171], v[160:161]
    v_pk_mul_f32 v[172:173], v[172:173], v[160:161]
    v_pk_mul_f32 v[174:175], v[174:175], v[160:161]
    v_cvt_pk_bf16_f32 v192, v168, v169
    v_cvt_pk_bf16_f32 v193, v170, v171
    v_cvt_pk_bf16_f32 v194, v172, v173
    v_cvt_pk_bf16_f32 v195, v174, v175
    s_waitcnt lgkmcnt(2)
    v_lshlrev_b32 v168, 16, v196
    v_and_b32 v169, 0xffff0000, v196
    v_lshlrev_b32 v170, 16, v197
    v_and_b32 v171, 0xffff0000, v197
    v_lshlrev_b32 v172, 16, v198
    v_and_b32 v173, 0xffff0000, v198
    v_lshlrev_b32 v174, 16, v199
    v_and_b32 v175, 0xffff0000, v199
    v_pk_mul_f32 v[168:169], v[168:169], v[160:161]
    v_pk_mul_f32 v[170:171], v[170:171], v[160:161]
    v_pk_mul_f32 v[172:173], v[172:173], v[160:161]
    v_pk_mul_f32 v[174:175], v[174:175], v[160:161]
    v_cvt_pk_bf16_f32 v196, v168, v169
    v_cvt_pk_bf16_f32 v197, v170, v171
    v_cvt_pk_bf16_f32 v198, v172, v173
    v_cvt_pk_bf16_f32 v199, v174, v175
    s_waitcnt lgkmcnt(1)
    v_lshlrev_b32 v168, 16, v200
    v_and_b32 v169, 0xffff0000, v200
    v_lshlrev_b32 v170, 16, v201
    v_and_b32 v171, 0xffff0000, v201
    v_lshlrev_b32 v172, 16, v202
    v_and_b32 v173, 0xffff0000, v202
    v_lshlrev_b32 v174, 16, v203
    v_and_b32 v175, 0xffff0000, v203
    v_pk_mul_f32 v[168:169], v[168:169], v[160:161]
    v_pk_mul_f32 v[170:171], v[170:171], v[160:161]
    v_pk_mul_f32 v[172:173], v[172:173], v[160:161]
    v_pk_mul_f32 v[174:175], v[174:175], v[160:161]
    v_cvt_pk_bf16_f32 v200, v168, v169
    v_cvt_pk_bf16_f32 v201, v170, v171
    v_cvt_pk_bf16_f32 v202, v172, v173
    v_cvt_pk_bf16_f32 v203, v174, v175
    s_waitcnt lgkmcnt(0)
    v_lshlrev_b32 v168, 16, v204
    v_and_b32 v169, 0xffff0000, v204
    v_lshlrev_b32 v170, 16, v205
    v_and_b32 v171, 0xffff0000, v205
    v_lshlrev_b32 v172, 16, v206
    v_and_b32 v173, 0xffff0000, v206
    v_lshlrev_b32 v174, 16, v207
    v_and_b32 v175, 0xffff0000, v207
    v_pk_mul_f32 v[168:169], v[168:169], v[160:161]
    v_pk_mul_f32 v[170:171], v[170:171], v[160:161]
    v_pk_mul_f32 v[172:173], v[172:173], v[160:161]
    v_pk_mul_f32 v[174:175], v[174:175], v[160:161]
    v_cvt_pk_bf16_f32 v204, v168, v169
    v_cvt_pk_bf16_f32 v205, v170, v171
    v_cvt_pk_bf16_f32 v206, v172, v173
    v_cvt_pk_bf16_f32 v207, v174, v175
    s_waitcnt vmcnt(8)
    s_barrier
    ds_read_b128 v[136:139], v8 offset:0
    ds_read_b128 v[140:143], v9 offset:0
    ds_read_b128 v[144:147], v10 offset:0
    ds_read_b128 v[148:151], v11 offset:0
    ds_read_b128 v[152:155], v8 offset:4096
    ds_read_b128 v[156:159], v9 offset:4096
    s_cmp_lt_u32 s71, s68
    s_cbranch_scc0 L_noqn
    s_add_u32 s90, s70, 1
    s_lshl_b32 s88, s90, 3
    s_add_u32 s88, s88, s65
    s_lshl_b32 s88, s88, 3
    s_add_u32 s88, s88, s69
    s_lshl_b32 s88, s88, 12
    s_lshl_b32 s89, s69, 12
    s_add_u32 m0, s89, 98304
    v_xor_b32 v161, 64, v29
    v_xor_b32 v162, 128, v29
    v_xor_b32 v163, 192, v29
    buffer_load_dwordx4 v29, s[28:31], s88 offen offset:0 lds
    buffer_load_dwordx4 v161, s[28:31], s88 offen offset:1024 lds
    buffer_load_dwordx4 v162, s[28:31], s88 offen offset:2048 lds
    buffer_load_dwordx4 v163, s[28:31], s88 offen offset:3072 lds
L_noqn:
    s_waitcnt lgkmcnt(0)
    v_mfma_f32_16x16x32_bf16 v[40:43], v[136:139], v[176:179], 0
    v_mfma_f32_16x16x32_bf16 v[44:47], v[136:139], v[192:195], 0
    ds_read_b128 v[136:139], v10 offset:4096
    v_mfma_f32_16x16x32_bf16 v[40:43], v[140:143], v[180:183], v[40:43]
    v_mfma_f32_16x16x32_bf16 v[44:47], v[140:143], v[196:199], v[44:47]
    ds_read_b128 v[140:143], v11 offset:4096
    v_mfma_f32_16x16x32_bf16 v[40:43], v[144:147], v[184:187], v[40:43]
    v_mfma_f32_16x16x32_bf16 v[44:47], v[144:147], v[200:203], v[44:47]
    v_mfma_f32_16x16x32_bf16 v[40:43], v[148:151], v[188:191], v[40:43]
    v_mfma_f32_16x16x32_bf16 v[44:47], v[148:151], v[204:207], v[44:47]
    v_mfma_f32_16x16x32_bf16 v[48:51], v[152:155], v[176:179], 0
    v_mfma_f32_16x16x32_bf16 v[52:55], v[152:155], v[192:195], 0
    v_mfma_f32_16x16x32_bf16 v[48:51], v[156:159], v[180:183], v[48:51]
    v_mfma_f32_16x16x32_bf16 v[52:55], v[156:159], v[196:199], v[52:55]
    s_waitcnt lgkmcnt(1)
    v_mfma_f32_16x16x32_bf16 v[48:51], v[136:139], v[184:187], v[48:51]
    v_mfma_f32_16x16x32_bf16 v[52:55], v[136:139], v[200:203], v[52:55]
    s_waitcnt lgkmcnt(0)
    v_mfma_f32_16x16x32_bf16 v[48:51], v[140:143], v[188:191], v[48:51]
    v_mfma_f32_16x16x32_bf16 v[52:55], v[140:143], v[204:207], v[52:55]
    s_add_u32 s77, s67, 1
    s_cmp_lg_u32 s67, s96
    s_cbranch_scc1 L_maskpb
    s_and_b32 s88, s72, 63
    s_lshl_b32 s89, s27, 5
    s_sub_i32 s88, s88, s89
    v_lshrrev_b32 v26, 4, v1
    v_lshlrev_b32 v26, 2, v26
    v_sub_u32 v26, s88, v26
    v_mov_b32 v25, 0xff800000
    s_nop 7
    v_cmp_lt_i32 vcc, 0, v26
    v_cmp_gt_i32 s[90:91], v26, 1
    s_nop 0
    v_cndmask_b32 v40, v25, v40, vcc
    v_cndmask_b32 v41, v25, v41, s[90:91]
    v_cndmask_b32 v44, v25, v44, vcc
    v_cndmask_b32 v45, v25, v45, s[90:91]
    v_cmp_lt_i32 vcc, 2, v26
    v_cmp_gt_i32 s[90:91], v26, 3
    s_nop 0
    v_cndmask_b32 v42, v25, v42, vcc
    v_cndmask_b32 v43, v25, v43, s[90:91]
    v_cndmask_b32 v46, v25, v46, vcc
    v_cndmask_b32 v47, v25, v47, s[90:91]
    v_cmp_lt_i32 vcc, 16, v26
    v_cmp_gt_i32 s[90:91], v26, 17
    s_nop 0
    v_cndmask_b32 v48, v25, v48, vcc
    v_cndmask_b32 v49, v25, v49, s[90:91]
    v_cndmask_b32 v52, v25, v52, vcc
    v_cndmask_b32 v53, v25, v53, s[90:91]
    v_cmp_lt_i32 vcc, 18, v26
    v_cmp_gt_i32 s[90:91], v26, 19
    s_nop 0
    v_cndmask_b32 v50, v25, v50, vcc
    v_cndmask_b32 v51, v25, v51, s[90:91]
    v_cndmask_b32 v54, v25, v54, vcc
    v_cndmask_b32 v55, v25, v55, s[90:91]
L_maskpb:
    s_nop 7
    v_max3_f32 v24, v40, v41, v42
    v_max3_f32 v24, v24, v43, v48
    v_max3_f32 v24, v24, v49, v50
    v_max_f32 v24, v24, v51
    v_max3_f32 v25, v44, v45, v46
    v_max3_f32 v25, v25, v47, v52
    v_max3_f32 v25, v25, v53, v54
    v_max_f32 v25, v25, v55
    s_nop 1
    v_permlane32_swap_b32 v24, v25
    v_max_f32 v24, v24, v25
    v_mov_b32 v25, v24
    s_nop 1
    v_permlane16_swap_b32 v24, v25
    v_max_f32 v24, v24, v25
    v_max_f32 v24, 0xff000000, v24
    v_mov_b32 v20, v24
    v_mov_b32 v25, v24
    s_nop 1
    v_permlane32_swap_b32 v24, v25
    v_sub_f32 v208, 0, v24
    v_sub_f32 v209, 0, v24
    v_sub_f32 v210, 0, v24
    v_sub_f32 v211, 0, v24
    v_sub_f32 v40, v40, v24
    v_sub_f32 v41, v41, v24
    v_sub_f32 v42, v42, v24
    v_sub_f32 v43, v43, v24
    v_sub_f32 v48, v48, v24
    v_sub_f32 v49, v49, v24
    v_sub_f32 v50, v50, v24
    v_sub_f32 v51, v51, v24
    v_sub_f32 v212, 0, v25
    v_sub_f32 v213, 0, v25
    v_sub_f32 v214, 0, v25
    v_sub_f32 v215, 0, v25
    v_sub_f32 v44, v44, v25
    v_sub_f32 v45, v45, v25
    v_sub_f32 v46, v46, v25
    v_sub_f32 v47, v47, v25
    v_sub_f32 v52, v52, v25
    v_sub_f32 v53, v53, v25
    v_sub_f32 v54, v54, v25
    v_sub_f32 v55, v55, v25
    s_cmp_lg_u32 s27, 0
    s_cbranch_scc1 L_top6
L_top0:
    s_cmp_eq_u32 s77, s87
    s_cbranch_scc1 L_seg0
L_segb0:
    s_waitcnt vmcnt(4)
    s_barrier
    ds_read_b128 v[136:139], v8 offset:16384
    v_readlane_b32 s79, v2, s93
    ds_read_b128 v[140:143], v9 offset:16384
    s_mov_b32 m0, s24
    ds_read_b128 v[144:147], v10 offset:16384
    s_cmp_lt_u32 s93, s76
    s_cselect_b32 s22, 134348800, 0
    ds_read_b128 v[148:151], v11 offset:16384
    v_exp_f32 v40, v40
    v_exp_f32 v41, v41
    ds_read_b128 v[152:155], v8 offset:20480
    v_exp_f32 v42, v42
    v_exp_f32 v43, v43
    ds_read_b128 v[156:159], v9 offset:20480
    s_waitcnt vmcnt(2)
    buffer_load_dwordx4 v4, s[20:23], s79 offen offset:0 nt lds
    v_cvt_pk_bf16_f32 v32, v40, v41
    v_exp_f32 v48, v48
    s_waitcnt lgkmcnt(5)
    v_mfma_f32_16x16x32_bf16 v[56:59], v[136:139], v[176:179], v[208:211]
    v_exp_f32 v49, v49
    v_mfma_f32_16x16x32_bf16 v[60:63], v[136:139], v[192:195], v[212:215]
    ds_read_b128 v[136:139], v10 offset:20480
    v_cvt_pk_bf16_f32 v33, v42, v43
    v_exp_f32 v50, v50
    s_waitcnt lgkmcnt(5)
    v_mfma_f32_16x16x32_bf16 v[56:59], v[140:143], v[180:183], v[56:59]
    v_exp_f32 v51, v51
    v_mfma_f32_16x16x32_bf16 v[60:63], v[140:143], v[196:199], v[60:63]
    ds_read_b128 v[140:143], v11 offset:20480
    v_cvt_pk_bf16_f32 v34, v48, v49
    v_exp_f32 v44, v44
    s_waitcnt lgkmcnt(5)
    v_mfma_f32_16x16x32_bf16 v[56:59], v[144:147], v[184:187], v[56:59]
    v_exp_f32 v45, v45
    v_mfma_f32_16x16x32_bf16 v[60:63], v[144:147], v[200:203], v[60:63]
    v_cvt_pk_bf16_f32 v35, v50, v51
    v_exp_f32 v46, v46
    s_waitcnt lgkmcnt(4)
    v_mfma_f32_16x16x32_bf16 v[56:59], v[148:151], v[188:191], v[56:59]
    v_exp_f32 v47, v47
    v_mfma_f32_16x16x32_bf16 v[60:63], v[148:151], v[204:207], v[60:63]
    v_cvt_pk_bf16_f32 v36, v44, v45
    v_exp_f32 v52, v52
    s_waitcnt vmcnt(2)
    buffer_load_dwordx4 v5, s[20:23], s79 offen offset:1024 nt lds
    s_waitcnt lgkmcnt(3)
    v_mfma_f32_16x16x32_bf16 v[64:67], v[152:155], v[176:179], v[208:211]
    v_exp_f32 v53, v53
    ds_read_b64_tr_b16 v[160:161], v12 offset:0
    v_mfma_f32_16x16x32_bf16 v[68:71], v[152:155], v[192:195], v[212:215]
    v_cvt_pk_bf16_f32 v37, v46, v47
    ds_read_b64_tr_b16 v[162:163], v12 offset:4096
    s_waitcnt lgkmcnt(4)
    v_mfma_f32_16x16x32_bf16 v[64:67], v[156:159], v[180:183], v[64:67]
    v_exp_f32 v54, v54
    ds_read_b64_tr_b16 v[164:165], v13 offset:0
    v_mfma_f32_16x16x32_bf16 v[68:71], v[156:159], v[196:199], v[68:71]
    v_exp_f32 v55, v55
    ds_read_b64_tr_b16 v[166:167], v13 offset:4096
    s_waitcnt lgkmcnt(5)
    v_mfma_f32_16x16x32_bf16 v[64:67], v[136:139], v[184:187], v[64:67]
    v_cvt_pk_bf16_f32 v38, v52, v53
    ds_read_b64_tr_b16 v[168:169], v14 offset:0
    v_mfma_f32_16x16x32_bf16 v[68:71], v[136:139], v[200:203], v[68:71]
    v_add_f32 v21, v21, v40
    ds_read_b64_tr_b16 v[170:171], v14 offset:4096
    s_waitcnt lgkmcnt(6)
    v_mfma_f32_16x16x32_bf16 v[64:67], v[140:143], v[188:191], v[64:67]
    v_cvt_pk_bf16_f32 v39, v54, v55
    ds_read_b64_tr_b16 v[172:173], v15 offset:0
    v_mfma_f32_16x16x32_bf16 v[68:71], v[140:143], v[204:207], v[68:71]
    ds_read_b64_tr_b16 v[174:175], v15 offset:4096
    s_waitcnt vmcnt(2)
    buffer_load_dwordx4 v6, s[20:23], s79 offen offset:2048 nt lds
    s_waitcnt lgkmcnt(6)
    v_mfma_f32_16x16x32_bf16 v[72:75], v[160:163], v[32:35], v[72:75]
    v_add_f32 v22, v22, v44
    v_add_f32 v21, v21, v41
    v_mfma_f32_16x16x32_bf16 v[76:79], v[160:163], v[36:39], v[76:79]
    ds_read_b64_tr_b16 v[160:161], v16 offset:0
    v_add_f32 v22, v22, v45
    ds_read_b64_tr_b16 v[162:163], v16 offset:4096
    s_waitcnt lgkmcnt(6)
    v_mfma_f32_16x16x32_bf16 v[80:83], v[164:167], v[32:35], v[80:83]
    v_add_f32 v21, v21, v42
    v_add_f32 v22, v22, v46
    v_mfma_f32_16x16x32_bf16 v[84:87], v[164:167], v[36:39], v[84:87]
    ds_read_b64_tr_b16 v[164:165], v17 offset:0
    v_add_f32 v21, v21, v43
    ds_read_b64_tr_b16 v[166:167], v17 offset:4096
    s_waitcnt lgkmcnt(6)
    v_mfma_f32_16x16x32_bf16 v[88:91], v[168:171], v[32:35], v[88:91]
    v_add_f32 v22, v22, v47
    v_add_f32 v21, v21, v48
    v_mfma_f32_16x16x32_bf16 v[92:95], v[168:171], v[36:39], v[92:95]
    ds_read_b64_tr_b16 v[168:169], v18 offset:0
    v_add_f32 v22, v22, v52
    ds_read_b64_tr_b16 v[170:171], v18 offset:4096
    s_cmp_eq_u32 s77, s96
    s_cbranch_scc1 L_mask0
L_maskb0:
    s_waitcnt lgkmcnt(6)
    v_mfma_f32_16x16x32_bf16 v[96:99], v[172:175], v[32:35], v[96:99]
    v_add_f32 v21, v21, v49
    v_add_f32 v22, v22, v53
    v_mfma_f32_16x16x32_bf16 v[100:103], v[172:175], v[36:39], v[100:103]
    ds_read_b64_tr_b16 v[172:173], v19 offset:0
    v_add_f32 v21, v21, v50
    ds_read_b64_tr_b16 v[174:175], v19 offset:4096
    s_waitcnt vmcnt(2)
    buffer_load_dwordx4 v7, s[20:23], s79 offen offset:3072 nt lds
    s_waitcnt lgkmcnt(6)
    v_mfma_f32_16x16x32_bf16 v[104:107], v[160:163], v[32:35], v[104:107]
    v_add_f32 v22, v22, v54
    v_add_f32 v21, v21, v51
    v_mfma_f32_16x16x32_bf16 v[108:111], v[160:163], v[36:39], v[108:111]
    v_add_f32 v22, v22, v55
    v_max3_f32 v24, v56, v57, v58
    s_add_u32 s93, s93, 1
    s_add_u32 s75, s75, 1
    s_waitcnt lgkmcnt(4)
    v_mfma_f32_16x16x32_bf16 v[112:115], v[164:167], v[32:35], v[112:115]
    v_max3_f32 v25, v59, v60, v61
    v_max3_f32 v24, v24, v62, v63
    v_mfma_f32_16x16x32_bf16 v[116:119], v[164:167], v[36:39], v[116:119]
    v_max3_f32 v25, v25, v64, v65
    v_max3_f32 v24, v24, v66, v67
    s_add_u32 s77, s77, 1
    s_mov_b32 s97, 1
    s_waitcnt lgkmcnt(2)
    v_mfma_f32_16x16x32_bf16 v[120:123], v[168:171], v[32:35], v[120:123]
    v_max3_f32 v25, v25, v68, v69
    v_max3_f32 v24, v24, v70, v71
    v_mfma_f32_16x16x32_bf16 v[124:127], v[168:171], v[36:39], v[124:127]
    v_max_f32 v24, v24, v25
    v_cmp_lt_f32 vcc, s92, v24
    s_cmp_lg_u32 s84, 0
    s_waitcnt lgkmcnt(0)
    v_mfma_f32_16x16x32_bf16 v[128:131], v[172:175], v[32:35], v[128:131]
    v_mfma_f32_16x16x32_bf16 v[132:135], v[172:175], v[36:39], v[132:135]
    s_cbranch_scc1 L_flush
    s_cbranch_vccnz L_resc1
L_top1:
    s_cmp_eq_u32 s77, s87
    s_cbranch_scc1 L_seg1
L_segb1:
    s_waitcnt vmcnt(4)
    s_barrier
    ds_read_b128 v[136:139], v8 offset:32768
    v_readlane_b32 s79, v2, s93
    ds_read_b128 v[140:143], v9 offset:32768
    s_mov_b32 m0, s25
    ds_read_b128 v[144:147], v10 offset:32768
    s_cmp_lt_u32 s93, s76
    s_cselect_b32 s22, 134348800, 0
    ds_read_b128 v[148:151], v11 offset:32768
    v_exp_f32 v56, v56
    v_exp_f32 v57, v57
    ds_read_b128 v[152:155], v8 offset:36864
    v_exp_f32 v58, v58
    v_exp_f32 v59, v59
    ds_read_b128 v[156:159], v9 offset:36864
    s_waitcnt vmcnt(2)
    buffer_load_dwordx4 v4, s[20:23], s79 offen offset:0 nt lds
    v_cvt_pk_bf16_f32 v32, v56, v57
    v_exp_f32 v64, v64
    s_waitcnt lgkmcnt(5)
    v_mfma_f32_16x16x32_bf16 v[40:43], v[136:139], v[176:179], v[208:211]
    v_exp_f32 v65, v65
    v_mfma_f32_16x16x32_bf16 v[44:47], v[136:139], v[192:195], v[212:215]
    ds_read_b128 v[136:139], v10 offset:36864
    v_cvt_pk_bf16_f32 v33, v58, v59
    v_exp_f32 v66, v66
    s_waitcnt lgkmcnt(5)
    v_mfma_f32_16x16x32_bf16 v[40:43], v[140:143], v[180:183], v[40:43]
    v_exp_f32 v67, v67
    v_mfma_f32_16x16x32_bf16 v[44:47], v[140:143], v[196:199], v[44:47]
    ds_read_b128 v[140:143], v11 offset:36864
    v_cvt_pk_bf16_f32 v34, v64, v65
    v_exp_f32 v60, v60
    s_waitcnt lgkmcnt(5)
    v_mfma_f32_16x16x32_bf16 v[40:43], v[144:147], v[184:187], v[40:43]
    v_exp_f32 v61, v61
    v_mfma_f32_16x16x32_bf16 v[44:47], v[144:147], v[200:203], v[44:47]
    v_cvt_pk_bf16_f32 v35, v66, v67
    v_exp_f32 v62, v62
    s_waitcnt lgkmcnt(4)
    v_mfma_f32_16x16x32_bf16 v[40:43], v[148:151], v[188:191], v[40:43]
    v_exp_f32 v63, v63
    v_mfma_f32_16x16x32_bf16 v[44:47], v[148:151], v[204:207], v[44:47]
    v_cvt_pk_bf16_f32 v36, v60, v61
    v_exp_f32 v68, v68
    s_waitcnt vmcnt(2)
    buffer_load_dwordx4 v5, s[20:23], s79 offen offset:1024 nt lds
    s_waitcnt lgkmcnt(3)
    v_mfma_f32_16x16x32_bf16 v[48:51], v[152:155], v[176:179], v[208:211]
    v_exp_f32 v69, v69
    ds_read_b64_tr_b16 v[160:161], v12 offset:16384
    v_mfma_f32_16x16x32_bf16 v[52:55], v[152:155], v[192:195], v[212:215]
    v_cvt_pk_bf16_f32 v37, v62, v63
    ds_read_b64_tr_b16 v[162:163], v12 offset:20480
    s_waitcnt lgkmcnt(4)
    v_mfma_f32_16x16x32_bf16 v[48:51], v[156:159], v[180:183], v[48:51]
    v_exp_f32 v70, v70
    ds_read_b64_tr_b16 v[164:165], v13 offset:16384
    v_mfma_f32_16x16x32_bf16 v[52:55], v[156:159], v[196:199], v[52:55]
    v_exp_f32 v71, v71
    ds_read_b64_tr_b16 v[166:167], v13 offset:20480
    s_waitcnt lgkmcnt(5)
    v_mfma_f32_16x16x32_bf16 v[48:51], v[136:139], v[184:187], v[48:51]
    v_cvt_pk_bf16_f32 v38, v68, v69
    ds_read_b64_tr_b16 v[168:169], v14 offset:16384
    v_mfma_f32_16x16x32_bf16 v[52:55], v[136:139], v[200:203], v[52:55]
    v_add_f32 v21, v21, v56
    ds_read_b64_tr_b16 v[170:171], v14 offset:20480
    s_waitcnt lgkmcnt(6)
    v_mfma_f32_16x16x32_bf16 v[48:51], v[140:143], v[188:191], v[48:51]
    v_cvt_pk_bf16_f32 v39, v70, v71
    ds_read_b64_tr_b16 v[172:173], v15 offset:16384
    v_mfma_f32_16x16x32_bf16 v[52:55], v[140:143], v[204:207], v[52:55]
    ds_read_b64_tr_b16 v[174:175], v15 offset:20480
    s_waitcnt vmcnt(2)
    buffer_load_dwordx4 v6, s[20:23], s79 offen offset:2048 nt lds
    s_waitcnt lgkmcnt(6)
    v_mfma_f32_16x16x32_bf16 v[72:75], v[160:163], v[32:35], v[72:75]
    v_add_f32 v22, v22, v60
    v_add_f32 v21, v21, v57
    v_mfma_f32_16x16x32_bf16 v[76:79], v[160:163], v[36:39], v[76:79]
    ds_read_b64_tr_b16 v[160:161], v16 offset:16384
    v_add_f32 v22, v22, v61
    ds_read_b64_tr_b16 v[162:163], v16 offset:20480
    s_waitcnt lgkmcnt(6)
    v_mfma_f32_16x16x32_bf16 v[80:83], v[164:167], v[32:35], v[80:83]
    v_add_f32 v21, v21, v58
    v_add_f32 v22, v22, v62
    v_mfma_f32_16x16x32_bf16 v[84:87], v[164:167], v[36:39], v[84:87]
    ds_read_b64_tr_b16 v[164:165], v17 offset:16384
    v_add_f32 v21, v21, v59
    ds_read_b64_tr_b16 v[166:167], v17 offset:20480
    s_waitcnt lgkmcnt(6)
    v_mfma_f32_16x16x32_bf16 v[88:91], v[168:171], v[32:35], v[88:91]
    v_add_f32 v22, v22, v63
    v_add_f32 v21, v21, v64
    v_mfma_f32_16x16x32_bf16 v[92:95], v[168:171], v[36:39], v[92:95]
    ds_read_b64_tr_b16 v[168:169], v18 offset:16384
    v_add_f32 v22, v22, v68
    ds_read_b64_tr_b16 v[170:171], v18 offset:20480
    s_cmp_eq_u32 s77, s96
    s_cbranch_scc1 L_mask1
L_maskb1:
    s_waitcnt lgkmcnt(6)
    v_mfma_f32_16x16x32_bf16 v[96:99], v[172:175], v[32:35], v[96:99]
    v_add_f32 v21, v21, v65
    v_add_f32 v22, v22, v69
    v_mfma_f32_16x16x32_bf16 v[100:103], v[172:175], v[36:39], v[100:103]
    ds_read_b64_tr_b16 v[172:173], v19 offset:16384
    v_add_f32 v21, v21, v66
    ds_read_b64_tr_b16 v[174:175], v19 offset:20480
    s_waitcnt vmcnt(2)
    buffer_load_dwordx4 v7, s[20:23], s79 offen offset:3072 nt lds
    s_waitcnt lgkmcnt(6)
    v_mfma_f32_16x16x32_bf16 v[104:107], v[160:163], v[32:35], v[104:107]
    v_add_f32 v22, v22, v70
    v_add_f32 v21, v21, v67
    v_mfma_f32_16x16x32_bf16 v[108:111], v[160:163], v[36:39], v[108:111]
    v_add_f32 v22, v22, v71
    v_max3_f32 v24, v40, v41, v42
    s_add_u32 s93, s93, 1
    s_add_u32 s75, s75, 1
    s_waitcnt lgkmcnt(4)
    v_mfma_f32_16x16x32_bf16 v[112:115], v[164:167], v[32:35], v[112:115]
    v_max3_f32 v25, v43, v44, v45
    v_max3_f32 v24, v24, v46, v47
    v_mfma_f32_16x16x32_bf16 v[116:119], v[164:167], v[36:39], v[116:119]
    v_max3_f32 v25, v25, v48, v49
    v_max3_f32 v24, v24, v50, v51
    s_add_u32 s77, s77, 1
    s_mov_b32 s97, 2
    s_waitcnt lgkmcnt(2)
    v_mfma_f32_16x16x32_bf16 v[120:123], v[168:171], v[32:35], v[120:123]
    v_max3_f32 v25, v25, v52, v53
    v_max3_f32 v24, v24, v54, v55
    v_mfma_f32_16x16x32_bf16 v[124:127], v[168:171], v[36:39], v[124:127]
    v_max_f32 v24, v24, v25
    v_cmp_lt_f32 vcc, s92, v24
    s_cmp_lg_u32 s84, 0
    s_waitcnt lgkmcnt(0)
    v_mfma_f32_16x16x32_bf16 v[128:131], v[172:175], v[32:35], v[128:131]
    v_mfma_f32_16x16x32_bf16 v[132:135], v[172:175], v[36:39], v[132:135]
    s_cbranch_scc1 L_flush
    s_cbranch_vccnz L_resc0
L_top2:
    s_cmp_eq_u32 s77, s87
    s_cbranch_scc1 L_seg2
L_segb2:
    s_waitcnt vmcnt(4)
    s_barrier
    ds_read_b128 v[136:139], v8 offset:0
    v_readlane_b32 s79, v2, s93
    ds_read_b128 v[140:143], v9 offset:0
    s_mov_b32 m0, s26
    ds_read_b128 v[144:147], v10 offset:0
    s_cmp_lt_u32 s93, s76
    s_cselect_b32 s22, 134348800, 0
    ds_read_b128 v[148:151], v11 offset:0
    v_exp_f32 v40, v40
    v_exp_f32 v41, v41
    ds_read_b128 v[152:155], v8 offset:4096
    v_exp_f32 v42, v42
    v_exp_f32 v43, v43
    ds_read_b128 v[156:159], v9 offset:4096
    s_waitcnt vmcnt(2)
    buffer_load_dwordx4 v4, s[20:23], s79 offen offset:0 nt lds
    v_cvt_pk_bf16_f32 v32, v40, v41
    v_exp_f32 v48, v48
    s_waitcnt lgkmcnt(5)
    v_mfma_f32_16x16x32_bf16 v[56:59], v[136:139], v[176:179], v[208:211]
    v_exp_f32 v49, v49
    v_mfma_f32_16x16x32_bf16 v[60:63], v[136:139], v[192:195], v[212:215]
    ds_read_b128 v[136:139], v10 offset:4096
    v_cvt_pk_bf16_f32 v33, v42, v43
    v_exp_f32 v50, v50
    s_waitcnt lgkmcnt(5)
    v_mfma_f32_16x16x32_bf16 v[56:59], v[140:143], v[180:183], v[56:59]
    v_exp_f32 v51, v51
    v_mfma_f32_16x16x32_bf16 v[60:63], v[140:143], v[196:199], v[60:63]
    ds_read_b128 v[140:143], v11 offset:4096
    v_cvt_pk_bf16_f32 v34, v48, v49
    v_exp_f32 v44, v44
    s_waitcnt lgkmcnt(5)
    v_mfma_f32_16x16x32_bf16 v[56:59], v[144:147], v[184:187], v[56:59]
    v_exp_f32 v45, v45
    v_mfma_f32_16x16x32_bf16 v[60:63], v[144:147], v[200:203], v[60:63]
    v_cvt_pk_bf16_f32 v35, v50, v51
    v_exp_f32 v46, v46
    s_waitcnt lgkmcnt(4)
    v_mfma_f32_16x16x32_bf16 v[56:59], v[148:151], v[188:191], v[56:59]
    v_exp_f32 v47, v47
    v_mfma_f32_16x16x32_bf16 v[60:63], v[148:151], v[204:207], v[60:63]
    v_cvt_pk_bf16_f32 v36, v44, v45
    v_exp_f32 v52, v52
    s_waitcnt vmcnt(2)
    buffer_load_dwordx4 v5, s[20:23], s79 offen offset:1024 nt lds
    s_waitcnt lgkmcnt(3)
    v_mfma_f32_16x16x32_bf16 v[64:67], v[152:155], v[176:179], v[208:211]
    v_exp_f32 v53, v53
    ds_read_b64_tr_b16 v[160:161], v12 offset:32768
    v_mfma_f32_16x16x32_bf16 v[68:71], v[152:155], v[192:195], v[212:215]
    v_cvt_pk_bf16_f32 v37, v46, v47
    ds_read_b64_tr_b16 v[162:163], v12 offset:36864
    s_waitcnt lgkmcnt(4)
    v_mfma_f32_16x16x32_bf16 v[64:67], v[156:159], v[180:183], v[64:67]
    v_exp_f32 v54, v54
    ds_read_b64_tr_b16 v[164:165], v13 offset:32768
    v_mfma_f32_16x16x32_bf16 v[68:71], v[156:159], v[196:199], v[68:71]
    v_exp_f32 v55, v55
    ds_read_b64_tr_b16 v[166:167], v13 offset:36864
    s_waitcnt lgkmcnt(5)
    v_mfma_f32_16x16x32_bf16 v[64:67], v[136:139], v[184:187], v[64:67]
    v_cvt_pk_bf16_f32 v38, v52, v53
    ds_read_b64_tr_b16 v[168:169], v14 offset:32768
    v_mfma_f32_16x16x32_bf16 v[68:71], v[136:139], v[200:203], v[68:71]
    v_add_f32 v21, v21, v40
    ds_read_b64_tr_b16 v[170:171], v14 offset:36864
    s_waitcnt lgkmcnt(6)
    v_mfma_f32_16x16x32_bf16 v[64:67], v[140:143], v[188:191], v[64:67]
    v_cvt_pk_bf16_f32 v39, v54, v55
    ds_read_b64_tr_b16 v[172:173], v15 offset:32768
    v_mfma_f32_16x16x32_bf16 v[68:71], v[140:143], v[204:207], v[68:71]
    ds_read_b64_tr_b16 v[174:175], v15 offset:36864
    s_waitcnt vmcnt(2)
    buffer_load_dwordx4 v6, s[20:23], s79 offen offset:2048 nt lds
    s_waitcnt lgkmcnt(6)
    v_mfma_f32_16x16x32_bf16 v[72:75], v[160:163], v[32:35], v[72:75]
    v_add_f32 v22, v22, v44
    v_add_f32 v21, v21, v41
    v_mfma_f32_16x16x32_bf16 v[76:79], v[160:163], v[36:39], v[76:79]
    ds_read_b64_tr_b16 v[160:161], v16 offset:32768
    v_add_f32 v22, v22, v45
    ds_read_b64_tr_b16 v[162:163], v16 offset:36864
    s_waitcnt lgkmcnt(6)
    v_mfma_f32_16x16x32_bf16 v[80:83], v[164:167], v[32:35], v[80:83]
    v_add_f32 v21, v21, v42
    v_add_f32 v22, v22, v46
    v_mfma_f32_16x16x32_bf16 v[84:87], v[164:167], v[36:39], v[84:87]
    ds_read_b64_tr_b16 v[164:165], v17 offset:32768
    v_add_f32 v21, v21, v43
    ds_read_b64_tr_b16 v[166:167], v17 offset:36864
    s_waitcnt lgkmcnt(6)
    v_mfma_f32_16x16x32_bf16 v[88:91], v[168:171], v[32:35], v[88:91]
    v_add_f32 v22, v22, v47
    v_add_f32 v21, v21, v48
    v_mfma_f32_16x16x32_bf16 v[92:95], v[168:171], v[36:39], v[92:95]
    ds_read_b64_tr_b16 v[168:169], v18 offset:32768
    v_add_f32 v22, v22, v52
    ds_read_b64_tr_b16 v[170:171], v18 offset:36864
    s_cmp_eq_u32 s77, s96
    s_cbranch_scc1 L_mask2
L_maskb2:
    s_waitcnt lgkmcnt(6)
    v_mfma_f32_16x16x32_bf16 v[96:99], v[172:175], v[32:35], v[96:99]
    v_add_f32 v21, v21, v49
    v_add_f32 v22, v22, v53
    v_mfma_f32_16x16x32_bf16 v[100:103], v[172:175], v[36:39], v[100:103]
    ds_read_b64_tr_b16 v[172:173], v19 offset:32768
    v_add_f32 v21, v21, v50
    ds_read_b64_tr_b16 v[174:175], v19 offset:36864
    s_waitcnt vmcnt(2)
    buffer_load_dwordx4 v7, s[20:23], s79 offen offset:3072 nt lds
    s_waitcnt lgkmcnt(6)
    v_mfma_f32_16x16x32_bf16 v[104:107], v[160:163], v[32:35], v[104:107]
    v_add_f32 v22, v22, v54
    v_add_f32 v21, v21, v51
    v_mfma_f32_16x16x32_bf16 v[108:111], v[160:163], v[36:39], v[108:111]
    v_add_f32 v22, v22, v55
    v_max3_f32 v24, v56, v57, v58
    s_add_u32 s93, s93, 1
    s_add_u32 s75, s75, 1
    s_waitcnt lgkmcnt(4)
    v_mfma_f32_16x16x32_bf16 v[112:115], v[164:167], v[32:35], v[112:115]
    v_max3_f32 v25, v59, v60, v61
    v_max3_f32 v24, v24, v62, v63
    v_mfma_f32_16x16x32_bf16 v[116:119], v[164:167], v[36:39], v[116:119]
    v_max3_f32 v25, v25, v64, v65
    v_max3_f32 v24, v24, v66, v67
    s_add_u32 s77, s77, 1
    s_mov_b32 s97, 3
    s_waitcnt lgkmcnt(2)
    v_mfma_f32_16x16x32_bf16 v[120:123], v[168:171], v[32:35], v[120:123]
    v_max3_f32 v25, v25, v68, v69
    v_max3_f32 v24, v24, v70, v71
    v_mfma_f32_16x16x32_bf16 v[124:127], v[168:171], v[36:39], v[124:127]
    v_max_f32 v24, v24, v25
    v_cmp_lt_f32 vcc, s92, v24
    s_cmp_lg_u32 s84, 0
    s_waitcnt lgkmcnt(0)
    v_mfma_f32_16x16x32_bf16 v[128:131], v[172:175], v[32:35], v[128:131]
    v_mfma_f32_16x16x32_bf16 v[132:135], v[172:175], v[36:39], v[132:135]
    s_cbranch_scc1 L_flush
    s_cbranch_vccnz L_resc1
L_top3:
    s_cmp_eq_u32 s77, s87
    s_cbranch_scc1 L_seg3
L_segb3:
    s_waitcnt vmcnt(4)
    s_barrier
    ds_read_b128 v[136:139], v8 offset:16384
    v_readlane_b32 s79, v2, s93
    ds_read_b128 v[140:143], v9 offset:16384
    s_mov_b32 m0, s24
    ds_read_b128 v[144:147], v10 offset:16384
    s_cmp_lt_u32 s93, s76
    s_cselect_b32 s22, 134348800, 0
    ds_read_b128 v[148:151], v11 offset:16384
    v_exp_f32 v56, v56
    v_exp_f32 v57, v57
    ds_read_b128 v[152:155], v8 offset:20480
    v_exp_f32 v58, v58
    v_exp_f32 v59, v59
    ds_read_b128 v[156:159], v9 offset:20480
    s_waitcnt vmcnt(2)
    buffer_load_dwordx4 v4, s[20:23], s79 offen offset:0 nt lds
    v_cvt_pk_bf16_f32 v32, v56, v57
    v_exp_f32 v64, v64
    s_waitcnt lgkmcnt(5)
    v_mfma_f32_16x16x32_bf16 v[40:43], v[136:139], v[176:179], v[208:211]
    v_exp_f32 v65, v65
    v_mfma_f32_16x16x32_bf16 v[44:47], v[136:139], v[192:195], v[212:215]
    ds_read_b128 v[136:139], v10 offset:20480
    v_cvt_pk_bf16_f32 v33, v58, v59
    v_exp_f32 v66, v66
    s_waitcnt lgkmcnt(5)
    v_mfma_f32_16x16x32_bf16 v[40:43], v[140:143], v[180:183], v[40:43]
    v_exp_f32 v67, v67
    v_mfma_f32_16x16x32_bf16 v[44:47], v[140:143], v[196:199], v[44:47]
    ds_read_b128 v[140:143], v11 offset:20480
    v_cvt_pk_bf16_f32 v34, v64, v65
    v_exp_f32 v60, v60
    s_waitcnt lgkmcnt(5)
    v_mfma_f32_16x16x32_bf16 v[40:43], v[144:147], v[184:187], v[40:43]
    v_exp_f32 v61, v61
    v_mfma_f32_16x16x32_bf16 v[44:47], v[144:147], v[200:203], v[44:47]
    v_cvt_pk_bf16_f32 v35, v66, v67
    v_exp_f32 v62, v62
    s_waitcnt lgkmcnt(4)
    v_mfma_f32_16x16x32_bf16 v[40:43], v[148:151], v[188:191], v[40:43]
    v_exp_f32 v63, v63
    v_mfma_f32_16x16x32_bf16 v[44:47], v[148:151], v[204:207], v[44:47]
    v_cvt_pk_bf16_f32 v36, v60, v61
    v_exp_f32 v68, v68
    s_waitcnt vmcnt(2)
    buffer_load_dwordx4 v5, s[20:23], s79 offen offset:1024 nt lds
    s_waitcnt lgkmcnt(3)
    v_mfma_f32_16x16x32_bf16 v[48:51], v[152:155], v[176:179], v[208:211]
    v_exp_f32 v69, v69
    ds_read_b64_tr_b16 v[160:161], v12 offset:0
    v_mfma_f32_16x16x32_bf16 v[52:55], v[152:155], v[192:195], v[212:215]
    v_cvt_pk_bf16_f32 v37, v62, v63
    ds_read_b64_tr_b16 v[162:163], v12 offset:4096
    s_waitcnt lgkmcnt(4)
    v_mfma_f32_16x16x32_bf16 v[48:51], v[156:159], v[180:183], v[48:51]
    v_exp_f32 v70, v70
    ds_read_b64_tr_b16 v[164:165], v13 offset:0
    v_mfma_f32_16x16x32_bf16 v[52:55], v[156:159], v[196:199], v[52:55]
    v_exp_f32 v71, v71
    ds_read_b64_tr_b16 v[166:167], v13 offset:4096
    s_waitcnt lgkmcnt(5)
    v_mfma_f32_16x16x32_bf16 v[48:51], v[136:139], v[184:187], v[48:51]
    v_cvt_pk_bf16_f32 v38, v68, v69
    ds_read_b64_tr_b16 v[168:169], v14 offset:0
    v_mfma_f32_16x16x32_bf16 v[52:55], v[136:139], v[200:203], v[52:55]
    v_add_f32 v21, v21, v56
    ds_read_b64_tr_b16 v[170:171], v14 offset:4096
    s_waitcnt lgkmcnt(6)
    v_mfma_f32_16x16x32_bf16 v[48:51], v[140:143], v[188:191], v[48:51]
    v_cvt_pk_bf16_f32 v39, v70, v71
    ds_read_b64_tr_b16 v[172:173], v15 offset:0
    v_mfma_f32_16x16x32_bf16 v[52:55], v[140:143], v[204:207], v[52:55]
    ds_read_b64_tr_b16 v[174:175], v15 offset:4096
    s_waitcnt vmcnt(2)
    buffer_load_dwordx4 v6, s[20:23], s79 offen offset:2048 nt lds
    s_waitcnt lgkmcnt(6)
    v_mfma_f32_16x16x32_bf16 v[72:75], v[160:163], v[32:35], v[72:75]
    v_add_f32 v22, v22, v60
    v_add_f32 v21, v21, v57
    v_mfma_f32_16x16x32_bf16 v[76:79], v[160:163], v[36:39], v[76:79]
    ds_read_b64_tr_b16 v[160:161], v16 offset:0
    v_add_f32 v22, v22, v61
    ds_read_b64_tr_b16 v[162:163], v16 offset:4096
    s_waitcnt lgkmcnt(6)
    v_mfma_f32_16x16x32_bf16 v[80:83], v[164:167], v[32:35], v[80:83]
    v_add_f32 v21, v21, v58
    v_add_f32 v22, v22, v62
    v_mfma_f32_16x16x32_bf16 v[84:87], v[164:167], v[36:39], v[84:87]
    ds_read_b64_tr_b16 v[164:165], v17 offset:0
    v_add_f32 v21, v21, v59
    ds_read_b64_tr_b16 v[166:167], v17 offset:4096
    s_waitcnt lgkmcnt(6)
    v_mfma_f32_16x16x32_bf16 v[88:91], v[168:171], v[32:35], v[88:91]
    v_add_f32 v22, v22, v63
    v_add_f32 v21, v21, v64
    v_mfma_f32_16x16x32_bf16 v[92:95], v[168:171], v[36:39], v[92:95]
    ds_read_b64_tr_b16 v[168:169], v18 offset:0
    v_add_f32 v22, v22, v68
    ds_read_b64_tr_b16 v[170:171], v18 offset:4096
    s_cmp_eq_u32 s77, s96
    s_cbranch_scc1 L_mask3
L_maskb3:
    s_waitcnt lgkmcnt(6)
    v_mfma_f32_16x16x32_bf16 v[96:99], v[172:175], v[32:35], v[96:99]
    v_add_f32 v21, v21, v65
    v_add_f32 v22, v22, v69
    v_mfma_f32_16x16x32_bf16 v[100:103], v[172:175], v[36:39], v[100:103]
    ds_read_b64_tr_b16 v[172:173], v19 offset:0
    v_add_f32 v21, v21, v66
    ds_read_b64_tr_b16 v[174:175], v19 offset:4096
    s_waitcnt vmcnt(2)
    buffer_load_dwordx4 v7, s[20:23], s79 offen offset:3072 nt lds
    s_waitcnt lgkmcnt(6)
    v_mfma_f32_16x16x32_bf16 v[104:107], v[160:163], v[32:35], v[104:107]
    v_add_f32 v22, v22, v70
    v_add_f32 v21, v21, v67
    v_mfma_f32_16x16x32_bf16 v[108:111], v[160:163], v[36:39], v[108:111]
    v_add_f32 v22, v22, v71
    v_max3_f32 v24, v40, v41, v42
    s_add_u32 s93, s93, 1
    s_add_u32 s75, s75, 1
    s_waitcnt lgkmcnt(4)
    v_mfma_f32_16x16x32_bf16 v[112:115], v[164:167], v[32:35], v[112:115]
    v_max3_f32 v25, v43, v44, v45
    v_max3_f32 v24, v24, v46, v47
    v_mfma_f32_16x16x32_bf16 v[116:119], v[164:167], v[36:39], v[116:119]
    v_max3_f32 v25, v25, v48, v49
    v_max3_f32 v24, v24, v50, v51
    s_add_u32 s77, s77, 1
    s_mov_b32 s97, 4
    s_waitcnt lgkmcnt(2)
    v_mfma_f32_16x16x32_bf16 v[120:123], v[168:171], v[32:35], v[120:123]
    v_max3_f32 v25, v25, v52, v53
    v_max3_f32 v24, v24, v54, v55
    v_mfma_f32_16x16x32_bf16 v[124:127], v[168:171], v[36:39], v[124:127]
    v_max_f32 v24, v24, v25
    v_cmp_lt_f32 vcc, s92, v24
    s_cmp_lg_u32 s84, 0
    s_waitcnt lgkmcnt(0)
    v_mfma_f32_16x16x32_bf16 v[128:131], v[172:175], v[32:35], v[128:131]
    v_mfma_f32_16x16x32_bf16 v[132:135], v[172:175], v[36:39], v[132:135]
    s_cbranch_scc1 L_flush
    s_cbranch_vccnz L_resc0
L_top4:
    s_cmp_eq_u32 s77, s87
    s_cbranch_scc1 L_seg4
L_segb4:
    s_waitcnt vmcnt(4)
    s_barrier
    ds_read_b128 v[136:139], v8 offset:32768
    v_readlane_b32 s79, v2, s93
    ds_read_b128 v[140:143], v9 offset:32768
    s_mov_b32 m0, s25
    ds_read_b128 v[144:147], v10 offset:32768
    s_cmp_lt_u32 s93, s76
    s_cselect_b32 s22, 134348800, 0
    ds_read_b128 v[148:151], v11 offset:32768
    v_exp_f32 v40, v40
    v_exp_f32 v41, v41
    ds_read_b128 v[152:155], v8 offset:36864
    v_exp_f32 v42, v42
    v_exp_f32 v43, v43
    ds_read_b128 v[156:159], v9 offset:36864
    s_waitcnt vmcnt(2)
    buffer_load_dwordx4 v4, s[20:23], s79 offen offset:0 nt lds
    v_cvt_pk_bf16_f32 v32, v40, v41
    v_exp_f32 v48, v48
    s_waitcnt lgkmcnt(5)
    v_mfma_f32_16x16x32_bf16 v[56:59], v[136:139], v[176:179], v[208:211]
    v_exp_f32 v49, v49
    v_mfma_f32_16x16x32_bf16 v[60:63], v[136:139], v[192:195], v[212:215]
    ds_read_b128 v[136:139], v10 offset:36864
    v_cvt_pk_bf16_f32 v33, v42, v43
    v_exp_f32 v50, v50
    s_waitcnt lgkmcnt(5)
    v_mfma_f32_16x16x32_bf16 v[56:59], v[140:143], v[180:183], v[56:59]
    v_exp_f32 v51, v51
    v_mfma_f32_16x16x32_bf16 v[60:63], v[140:143], v[196:199], v[60:63]
    ds_read_b128 v[140:143], v11 offset:36864
    v_cvt_pk_bf16_f32 v34, v48, v49
    v_exp_f32 v44, v44
    s_waitcnt lgkmcnt(5)
    v_mfma_f32_16x16x32_bf16 v[56:59], v[144:147], v[184:187], v[56:59]
    v_exp_f32 v45, v45
    v_mfma_f32_16x16x32_bf16 v[60:63], v[144:147], v[200:203], v[60:63]
    v_cvt_pk_bf16_f32 v35, v50, v51
    v_exp_f32 v46, v46
    s_waitcnt lgkmcnt(4)
    v_mfma_f32_16x16x32_bf16 v[56:59], v[148:151], v[188:191], v[56:59]
    v_exp_f32 v47, v47
    v_mfma_f32_16x16x32_bf16 v[60:63], v[148:151], v[204:207], v[60:63]
    v_cvt_pk_bf16_f32 v36, v44, v45
    v_exp_f32 v52, v52
    s_waitcnt vmcnt(2)
    buffer_load_dwordx4 v5, s[20:23], s79 offen offset:1024 nt lds
    s_waitcnt lgkmcnt(3)
    v_mfma_f32_16x16x32_bf16 v[64:67], v[152:155], v[176:179], v[208:211]
    v_exp_f32 v53, v53
    ds_read_b64_tr_b16 v[160:161], v12 offset:16384
    v_mfma_f32_16x16x32_bf16 v[68:71], v[152:155], v[192:195], v[212:215]
    v_cvt_pk_bf16_f32 v37, v46, v47
    ds_read_b64_tr_b16 v[162:163], v12 offset:20480
    s_waitcnt lgkmcnt(4)
    v_mfma_f32_16x16x32_bf16 v[64:67], v[156:159], v[180:183], v[64:67]
    v_exp_f32 v54, v54
    ds_read_b64_tr_b16 v[164:165], v13 offset:16384
    v_mfma_f32_16x16x32_bf16 v[68:71], v[156:159], v[196:199], v[68:71]
    v_exp_f32 v55, v55
    ds_read_b64_tr_b16 v[166:167], v13 offset:20480
    s_waitcnt lgkmcnt(5)
    v_mfma_f32_16x16x32_bf16 v[64:67], v[136:139], v[184:187], v[64:67]
    v_cvt_pk_bf16_f32 v38, v52, v53
    ds_read_b64_tr_b16 v[168:169], v14 offset:16384
    v_mfma_f32_16x16x32_bf16 v[68:71], v[136:139], v[200:203], v[68:71]
    v_add_f32 v21, v21, v40
    ds_read_b64_tr_b16 v[170:171], v14 offset:20480
    s_waitcnt lgkmcnt(6)
    v_mfma_f32_16x16x32_bf16 v[64:67], v[140:143], v[188:191], v[64:67]
    v_cvt_pk_bf16_f32 v39, v54, v55
    ds_read_b64_tr_b16 v[172:173], v15 offset:16384
    v_mfma_f32_16x16x32_bf16 v[68:71], v[140:143], v[204:207], v[68:71]
    ds_read_b64_tr_b16 v[174:175], v15 offset:20480
    s_waitcnt vmcnt(2)
    buffer_load_dwordx4 v6, s[20:23], s79 offen offset:2048 nt lds
    s_waitcnt lgkmcnt(6)
    v_mfma_f32_16x16x32_bf16 v[72:75], v[160:163], v[32:35], v[72:75]
    v_add_f32 v22, v22, v44
    v_add_f32 v21, v21, v41
    v_mfma_f32_16x16x32_bf16 v[76:79], v[160:163], v[36:39], v[76:79]
    ds_read_b64_tr_b16 v[160:161], v16 offset:16384
    v_add_f32 v22, v22, v45
    ds_read_b64_tr_b16 v[162:163], v16 offset:20480
    s_waitcnt lgkmcnt(6)
    v_mfma_f32_16x16x32_bf16 v[80:83], v[164:167], v[32:35], v[80:83]
    v_add_f32 v21, v21, v42
    v_add_f32 v22, v22, v46
    v_mfma_f32_16x16x32_bf16 v[84:87], v[164:167], v[36:39], v[84:87]
    ds_read_b64_tr_b16 v[164:165], v17 offset:16384
    v_add_f32 v21, v21, v43
    ds_read_b64_tr_b16 v[166:167], v17 offset:20480
    s_waitcnt lgkmcnt(6)
    v_mfma_f32_16x16x32_bf16 v[88:91], v[168:171], v[32:35], v[88:91]
    v_add_f32 v22, v22, v47
    v_add_f32 v21, v21, v48
    v_mfma_f32_16x16x32_bf16 v[92:95], v[168:171], v[36:39], v[92:95]
    ds_read_b64_tr_b16 v[168:169], v18 offset:16384
    v_add_f32 v22, v22, v52
    ds_read_b64_tr_b16 v[170:171], v18 offset:20480
    s_cmp_eq_u32 s77, s96
    s_cbranch_scc1 L_mask4
L_maskb4:
    s_waitcnt lgkmcnt(6)
    v_mfma_f32_16x16x32_bf16 v[96:99], v[172:175], v[32:35], v[96:99]
    v_add_f32 v21, v21, v49
    v_add_f32 v22, v22, v53
    v_mfma_f32_16x16x32_bf16 v[100:103], v[172:175], v[36:39], v[100:103]
    ds_read_b64_tr_b16 v[172:173], v19 offset:16384
    v_add_f32 v21, v21, v50
    ds_read_b64_tr_b16 v[174:175], v19 offset:20480
    s_waitcnt vmcnt(2)
    buffer_load_dwordx4 v7, s[20:23], s79 offen offset:3072 nt lds
    s_waitcnt lgkmcnt(6)
    v_mfma_f32_16x16x32_bf16 v[104:107], v[160:163], v[32:35], v[104:107]
    v_add_f32 v22, v22, v54
    v_add_f32 v21, v21, v51
    v_mfma_f32_16x16x32_bf16 v[108:111], v[160:163], v[36:39], v[108:111]
    v_add_f32 v22, v22, v55
    v_max3_f32 v24, v56, v57, v58
    s_add_u32 s93, s93, 1
    s_add_u32 s75, s75, 1
    s_waitcnt lgkmcnt(4)
    v_mfma_f32_16x16x32_bf16 v[112:115], v[164:167], v[32:35], v[112:115]
    v_max3_f32 v25, v59, v60, v61
    v_max3_f32 v24, v24, v62, v63
    v_mfma_f32_16x16x32_bf16 v[116:119], v[164:167], v[36:39], v[116:119]
    v_max3_f32 v25, v25, v64, v65
    v_max3_f32 v24, v24, v66, v67
    s_add_u32 s77, s77, 1
    s_mov_b32 s97, 5
    s_waitcnt lgkmcnt(2)
    v_mfma_f32_16x16x32_bf16 v[120:123], v[168:171], v[32:35], v[120:123]
    v_max3_f32 v25, v25, v68, v69
    v_max3_f32 v24, v24, v70, v71
    v_mfma_f32_16x16x32_bf16 v[124:127], v[168:171], v[36:39], v[124:127]
    v_max_f32 v24, v24, v25
    v_cmp_lt_f32 vcc, s92, v24
    s_cmp_lg_u32 s84, 0
    s_waitcnt lgkmcnt(0)
    v_mfma_f32_16x16x32_bf16 v[128:131], v[172:175], v[32:35], v[128:131]
    v_mfma_f32_16x16x32_bf16 v[132:135], v[172:175], v[36:39], v[132:135]
    s_cbranch_scc1 L_flush
    s_cbranch_vccnz L_resc1
L_top5:
    s_cmp_eq_u32 s77, s87
    s_cbranch_scc1 L_seg5
L_segb5:
    s_waitcnt vmcnt(4)
    s_barrier
    ds_read_b128 v[136:139], v8 offset:0
    v_readlane_b32 s79, v2, s93
    ds_read_b128 v[140:143], v9 offset:0
    s_mov_b32 m0, s26
    ds_read_b128 v[144:147], v10 offset:0
    s_cmp_lt_u32 s93, s76
    s_cselect_b32 s22, 134348800, 0
    ds_read_b128 v[148:151], v11 offset:0
    v_exp_f32 v56, v56
    v_exp_f32 v57, v57
    ds_read_b128 v[152:155], v8 offset:4096
    v_exp_f32 v58, v58
    v_exp_f32 v59, v59
    ds_read_b128 v[156:159], v9 offset:4096
    s_waitcnt vmcnt(2)
    buffer_load_dwordx4 v4, s[20:23], s79 offen offset:0 nt lds
    v_cvt_pk_bf16_f32 v32, v56, v57
    v_exp_f32 v64, v64
    s_waitcnt lgkmcnt(5)
    v_mfma_f32_16x16x32_bf16 v[40:43], v[136:139], v[176:179], v[208:211]
    v_exp_f32 v65, v65
    v_mfma_f32_16x16x32_bf16 v[44:47], v[136:139], v[192:195], v[212:215]
    ds_read_b128 v[136:139], v10 offset:4096
    v_cvt_pk_bf16_f32 v33, v58, v59
    v_exp_f32 v66, v66
    s_waitcnt lgkmcnt(5)
    v_mfma_f32_16x16x32_bf16 v[40:43], v[140:143], v[180:183], v[40:43]
    v_exp_f32 v67, v67
    v_mfma_f32_16x16x32_bf16 v[44:47], v[140:143], v[196:199], v[44:47]
    ds_read_b128 v[140:143], v11 offset:4096
    v_cvt_pk_bf16_f32 v34, v64, v65
    v_exp_f32 v60, v60
    s_waitcnt lgkmcnt(5)
    v_mfma_f32_16x16x32_bf16 v[40:43], v[144:147], v[184:187], v[40:43]
    v_exp_f32 v61, v61
    v_mfma_f32_16x16x32_bf16 v[44:47], v[144:147], v[200:203], v[44:47]
    v_cvt_pk_bf16_f32 v35, v66, v67
    v_exp_f32 v62, v62
    s_waitcnt lgkmcnt(4)
    v_mfma_f32_16x16x32_bf16 v[40:43], v[148:151], v[188:191], v[40:43]
    v_exp_f32 v63, v63
    v_mfma_f32_16x16x32_bf16 v[44:47], v[148:151], v[204:207], v[44:47]
    v_cvt_pk_bf16_f32 v36, v60, v61
    v_exp_f32 v68, v68
    s_waitcnt vmcnt(2)
    buffer_load_dwordx4 v5, s[20:23], s79 offen offset:1024 nt lds
    s_waitcnt lgkmcnt(3)
    v_mfma_f32_16x16x32_bf16 v[48:51], v[152:155], v[176:179], v[208:211]
    v_exp_f32 v69, v69
    ds_read_b64_tr_b16 v[160:161], v12 offset:32768
    v_mfma_f32_16x16x32_bf16 v[52:55], v[152:155], v[192:195], v[212:215]
    v_cvt_pk_bf16_f32 v37, v62, v63
    ds_read_b64_tr_b16 v[162:163], v12 offset:36864
    s_waitcnt lgkmcnt(4)
    v_mfma_f32_16x16x32_bf16 v[48:51], v[156:159], v[180:183], v[48:51]
    v_exp_f32 v70, v70
    ds_read_b64_tr_b16 v[164:165], v13 offset:32768
    v_mfma_f32_16x16x32_bf16 v[52:55], v[156:159], v[196:199], v[52:55]
    v_exp_f32 v71, v71
    ds_read_b64_tr_b16 v[166:167], v13 offset:36864
    s_waitcnt lgkmcnt(5)
    v_mfma_f32_16x16x32_bf16 v[48:51], v[136:139], v[184:187], v[48:51]
    v_cvt_pk_bf16_f32 v38, v68, v69
    ds_read_b64_tr_b16 v[168:169], v14 offset:32768
    v_mfma_f32_16x16x32_bf16 v[52:55], v[136:139], v[200:203], v[52:55]
    v_add_f32 v21, v21, v56
    ds_read_b64_tr_b16 v[170:171], v14 offset:36864
    s_waitcnt lgkmcnt(6)
    v_mfma_f32_16x16x32_bf16 v[48:51], v[140:143], v[188:191], v[48:51]
    v_cvt_pk_bf16_f32 v39, v70, v71
    ds_read_b64_tr_b16 v[172:173], v15 offset:32768
    v_mfma_f32_16x16x32_bf16 v[52:55], v[140:143], v[204:207], v[52:55]
    ds_read_b64_tr_b16 v[174:175], v15 offset:36864
    s_waitcnt vmcnt(2)
    buffer_load_dwordx4 v6, s[20:23], s79 offen offset:2048 nt lds
    s_waitcnt lgkmcnt(6)
    v_mfma_f32_16x16x32_bf16 v[72:75], v[160:163], v[32:35], v[72:75]
    v_add_f32 v22, v22, v60
    v_add_f32 v21, v21, v57
    v_mfma_f32_16x16x32_bf16 v[76:79], v[160:163], v[36:39], v[76:79]
    ds_read_b64_tr_b16 v[160:161], v16 offset:32768
    v_add_f32 v22, v22, v61
    ds_read_b64_tr_b16 v[162:163], v16 offset:36864
    s_waitcnt lgkmcnt(6)
    v_mfma_f32_16x16x32_bf16 v[80:83], v[164:167], v[32:35], v[80:83]
    v_add_f32 v21, v21, v58
    v_add_f32 v22, v22, v62
    v_mfma_f32_16x16x32_bf16 v[84:87], v[164:167], v[36:39], v[84:87]
    ds_read_b64_tr_b16 v[164:165], v17 offset:32768
    v_add_f32 v21, v21, v59
    ds_read_b64_tr_b16 v[166:167], v17 offset:36864
    s_waitcnt lgkmcnt(6)
    v_mfma_f32_16x16x32_bf16 v[88:91], v[168:171], v[32:35], v[88:91]
    v_add_f32 v22, v22, v63
    v_add_f32 v21, v21, v64
    v_mfma_f32_16x16x32_bf16 v[92:95], v[168:171], v[36:39], v[92:95]
    ds_read_b64_tr_b16 v[168:169], v18 offset:32768
    v_add_f32 v22, v22, v68
    ds_read_b64_tr_b16 v[170:171], v18 offset:36864
    s_cmp_eq_u32 s77, s96
    s_cbranch_scc1 L_mask5
L_maskb5:
    s_waitcnt lgkmcnt(6)
    v_mfma_f32_16x16x32_bf16 v[96:99], v[172:175], v[32:35], v[96:99]
    v_add_f32 v21, v21, v65
    v_add_f32 v22, v22, v69
    v_mfma_f32_16x16x32_bf16 v[100:103], v[172:175], v[36:39], v[100:103]
    ds_read_b64_tr_b16 v[172:173], v19 offset:32768
    v_add_f32 v21, v21, v66
    ds_read_b64_tr_b16 v[174:175], v19 offset:36864
    s_waitcnt vmcnt(2)
    buffer_load_dwordx4 v7, s[20:23], s79 offen offset:3072 nt lds
    s_waitcnt lgkmcnt(6)
    v_mfma_f32_16x16x32_bf16 v[104:107], v[160:163], v[32:35], v[104:107]
    v_add_f32 v22, v22, v70
    v_add_f32 v21, v21, v67
    v_mfma_f32_16x16x32_bf16 v[108:111], v[160:163], v[36:39], v[108:111]
    v_add_f32 v22, v22, v71
    v_max3_f32 v24, v40, v41, v42
    s_add_u32 s93, s93, 1
    s_add_u32 s75, s75, 1
    s_waitcnt lgkmcnt(4)
    v_mfma_f32_16x16x32_bf16 v[112:115], v[164:167], v[32:35], v[112:115]
    v_max3_f32 v25, v43, v44, v45
    v_max3_f32 v24, v24, v46, v47
    v_mfma_f32_16x16x32_bf16 v[116:119], v[164:167], v[36:39], v[116:119]
    v_max3_f32 v25, v25, v48, v49
    v_max3_f32 v24, v24, v50, v51
    s_add_u32 s77, s77, 1
    s_mov_b32 s97, 0
    s_waitcnt lgkmcnt(2)
    v_mfma_f32_16x16x32_bf16 v[120:123], v[168:171], v[32:35], v[120:123]
    v_max3_f32 v25, v25, v52, v53
    v_max3_f32 v24, v24, v54, v55
    v_mfma_f32_16x16x32_bf16 v[124:127], v[168:171], v[36:39], v[124:127]
    v_max_f32 v24, v24, v25
    v_cmp_lt_f32 vcc, s92, v24
    s_cmp_lg_u32 s84, 0
    s_waitcnt lgkmcnt(0)
    v_mfma_f32_16x16x32_bf16 v[128:131], v[172:175], v[32:35], v[128:131]
    v_mfma_f32_16x16x32_bf16 v[132:135], v[172:175], v[36:39], v[132:135]
    s_cbranch_scc1 L_flush
    s_cbranch_vccnz L_resc0
    s_branch L_top0
L_top6:
    s_cmp_eq_u32 s77, s87
    s_cbranch_scc1 L_seg6
L_segb6:
    s_waitcnt vmcnt(4)
    s_barrier
    ds_read_b128 v[136:139], v8 offset:16384
    v_readlane_b32 s79, v2, s93
    ds_read_b128 v[140:143], v9 offset:16384
    s_mov_b32 m0, s24
    ds_read_b128 v[144:147], v10 offset:16384
    s_cmp_lt_u32 s93, s76
    s_cselect_b32 s22, 134348800, 0
    ds_read_b128 v[148:151], v11 offset:16384
    v_exp_f32 v40, v40
    v_exp_f32 v41, v41
    ds_read_b128 v[152:155], v8 offset:20480
    v_exp_f32 v42, v42
    v_exp_f32 v43, v43
    ds_read_b128 v[156:159], v9 offset:20480
    s_waitcnt vmcnt(2)
    buffer_load_dwordx4 v4, s[20:23], s79 offen offset:0 nt lds
    v_cvt_pk_bf16_f32 v32, v40, v41
    v_exp_f32 v48, v48
    s_waitcnt lgkmcnt(5)
    v_mfma_f32_16x16x32_bf16 v[56:59], v[136:139], v[176:179], v[208:211]
    v_exp_f32 v49, v49
    v_mfma_f32_16x16x32_bf16 v[60:63], v[136:139], v[192:195], v[212:215]
    ds_read_b128 v[136:139], v10 offset:20480
    v_cvt_pk_bf16_f32 v33, v42, v43
    v_exp_f32 v50, v50
    s_waitcnt lgkmcnt(5)
    v_mfma_f32_16x16x32_bf16 v[56:59], v[140:143], v[180:183], v[56:59]
    v_exp_f32 v51, v51
    v_mfma_f32_16x16x32_bf16 v[60:63], v[140:143], v[196:199], v[60:63]
    ds_read_b128 v[140:143], v11 offset:20480
    v_cvt_pk_bf16_f32 v34, v48, v49
    v_exp_f32 v44, v44
    s_waitcnt lgkmcnt(5)
    v_mfma_f32_16x16x32_bf16 v[56:59], v[144:147], v[184:187], v[56:59]
    v_exp_f32 v45, v45
    v_mfma_f32_16x16x32_bf16 v[60:63], v[144:147], v[200:203], v[60:63]
    v_cvt_pk_bf16_f32 v35, v50, v51
    v_exp_f32 v46, v46
    s_waitcnt lgkmcnt(4)
    v_mfma_f32_16x16x32_bf16 v[56:59], v[148:151], v[188:191], v[56:59]
    v_exp_f32 v47, v47
    v_mfma_f32_16x16x32_bf16 v[60:63], v[148:151], v[204:207], v[60:63]
    v_cvt_pk_bf16_f32 v36, v44, v45
    v_exp_f32 v52, v52
    s_waitcnt vmcnt(2)
    buffer_load_dwordx4 v5, s[20:23], s79 offen offset:1024 nt lds
    s_waitcnt lgkmcnt(3)
    v_mfma_f32_16x16x32_bf16 v[64:67], v[152:155], v[176:179], v[208:211]
    v_exp_f32 v53, v53
    ds_read_b64_tr_b16 v[160:161], v12 offset:0
    v_mfma_f32_16x16x32_bf16 v[68:71], v[152:155], v[192:195], v[212:215]
    v_cvt_pk_bf16_f32 v37, v46, v47
    ds_read_b64_tr_b16 v[162:163], v12 offset:4096
    s_waitcnt lgkmcnt(4)
    v_mfma_f32_16x16x32_bf16 v[64:67], v[156:159], v[180:183], v[64:67]
    v_exp_f32 v54, v54
    ds_read_b64_tr_b16 v[164:165], v13 offset:0
    v_mfma_f32_16x16x32_bf16 v[68:71], v[156:159], v[196:199], v[68:71]
    v_exp_f32 v55, v55
    ds_read_b64_tr_b16 v[166:167], v13 offset:4096
    s_waitcnt lgkmcnt(5)
    v_mfma_f32_16x16x32_bf16 v[64:67], v[136:139], v[184:187], v[64:67]
    v_cvt_pk_bf16_f32 v38, v52, v53
    ds_read_b64_tr_b16 v[168:169], v14 offset:0
    v_mfma_f32_16x16x32_bf16 v[68:71], v[136:139], v[200:203], v[68:71]
    v_add_f32 v21, v21, v40
    ds_read_b64_tr_b16 v[170:171], v14 offset:4096
    s_waitcnt lgkmcnt(6)
    v_mfma_f32_16x16x32_bf16 v[64:67], v[140:143], v[188:191], v[64:67]
    v_cvt_pk_bf16_f32 v39, v54, v55
    ds_read_b64_tr_b16 v[172:173], v15 offset:0
    v_mfma_f32_16x16x32_bf16 v[68:71], v[140:143], v[204:207], v[68:71]
    ds_read_b64_tr_b16 v[174:175], v15 offset:4096
    s_waitcnt vmcnt(2)
    buffer_load_dwordx4 v6, s[20:23], s79 offen offset:2048 nt lds
    s_waitcnt lgkmcnt(6)
    v_mfma_f32_16x16x32_bf16 v[72:75], v[160:163], v[32:35], v[72:75]
    v_add_f32 v22, v22, v44
    v_add_f32 v21, v21, v41
    v_mfma_f32_16x16x32_bf16 v[76:79], v[160:163], v[36:39], v[76:79]
    ds_read_b64_tr_b16 v[160:161], v16 offset:0
    v_add_f32 v22, v22, v45
    ds_read_b64_tr_b16 v[162:163], v16 offset:4096
    s_waitcnt lgkmcnt(6)
    v_mfma_f32_16x16x32_bf16 v[80:83], v[164:167], v[32:35], v[80:83]
    v_add_f32 v21, v21, v42
    v_add_f32 v22, v22, v46
    v_mfma_f32_16x16x32_bf16 v[84:87], v[164:167], v[36:39], v[84:87]
    ds_read_b64_tr_b16 v[164:165], v17 offset:0
    v_add_f32 v21, v21, v43
    ds_read_b64_tr_b16 v[166:167], v17 offset:4096
    s_waitcnt lgkmcnt(6)
    v_mfma_f32_16x16x32_bf16 v[88:91], v[168:171], v[32:35], v[88:91]
    v_add_f32 v22, v22, v47
    v_add_f32 v21, v21, v48
    v_mfma_f32_16x16x32_bf16 v[92:95], v[168:171], v[36:39], v[92:95]
    ds_read_b64_tr_b16 v[168:169], v18 offset:0
    v_add_f32 v22, v22, v52
    ds_read_b64_tr_b16 v[170:171], v18 offset:4096
    s_cmp_eq_u32 s77, s96
    s_cbranch_scc1 L_mask6
L_maskb6:
    s_waitcnt lgkmcnt(6)
    v_mfma_f32_16x16x32_bf16 v[96:99], v[172:175], v[32:35], v[96:99]
    v_add_f32 v21, v21, v49
    v_add_f32 v22, v22, v53
    v_mfma_f32_16x16x32_bf16 v[100:103], v[172:175], v[36:39], v[100:103]
    ds_read_b64_tr_b16 v[172:173], v19 offset:0
    v_add_f32 v21, v21, v50
    ds_read_b64_tr_b16 v[174:175], v19 offset:4096
    s_waitcnt vmcnt(2)
    buffer_load_dwordx4 v7, s[20:23], s79 offen offset:3072 nt lds
    s_waitcnt lgkmcnt(6)
    v_mfma_f32_16x16x32_bf16 v[104:107], v[160:163], v[32:35], v[104:107]
    v_add_f32 v22, v22, v54
    v_add_f32 v21, v21, v51
    v_mfma_f32_16x16x32_bf16 v[108:111], v[160:163], v[36:39], v[108:111]
    v_add_f32 v22, v22, v55
    v_max3_f32 v24, v56, v57, v58
    s_add_u32 s93, s93, 1
    s_add_u32 s75, s75, 1
    s_waitcnt lgkmcnt(4)
    v_mfma_f32_16x16x32_bf16 v[112:115], v[164:167], v[32:35], v[112:115]
    v_max3_f32 v25, v59, v60, v61
    v_max3_f32 v24, v24, v62, v63
    v_mfma_f32_16x16x32_bf16 v[116:119], v[164:167], v[36:39], v[116:119]
    v_max3_f32 v25, v25, v64, v65
    v_max3_f32 v24, v24, v66, v67
    s_add_u32 s77, s77, 1
    s_mov_b32 s97, 7
    s_waitcnt lgkmcnt(2)
    v_mfma_f32_16x16x32_bf16 v[120:123], v[168:171], v[32:35], v[120:123]
    v_max3_f32 v25, v25, v68, v69
    v_max3_f32 v24, v24, v70, v71
    v_mfma_f32_16x16x32_bf16 v[124:127], v[168:171], v[36:39], v[124:127]
    v_max_f32 v24, v24, v25
    v_cmp_lt_f32 vcc, s92, v24
    s_cmp_lg_u32 s84, 0
    s_waitcnt lgkmcnt(0)
    v_mfma_f32_16x16x32_bf16 v[128:131], v[172:175], v[32:35], v[128:131]
    v_mfma_f32_16x16x32_bf16 v[132:135], v[172:175], v[36:39], v[132:135]
    s_cbranch_scc1 L_flush
    s_cbranch_vccnz L_resc1
L_top7:
    s_cmp_eq_u32 s77, s87
    s_cbranch_scc1 L_seg7
L_segb7:
    s_waitcnt vmcnt(4)
    s_barrier
    ds_read_b128 v[136:139], v8 offset:32768
    v_readlane_b32 s79, v2, s93
    ds_read_b128 v[140:143], v9 offset:32768
    s_mov_b32 m0, s25
    ds_read_b128 v[144:147], v10 offset:32768
    s_cmp_lt_u32 s93, s76
    s_cselect_b32 s22, 134348800, 0
    ds_read_b128 v[148:151], v11 offset:32768
    v_exp_f32 v56, v56
    v_exp_f32 v57, v57
    ds_read_b128 v[152:155], v8 offset:36864
    v_exp_f32 v58, v58
    v_exp_f32 v59, v59
    ds_read_b128 v[156:159], v9 offset:36864
    s_waitcnt vmcnt(2)
    buffer_load_dwordx4 v4, s[20:23], s79 offen offset:0 nt lds
    v_cvt_pk_bf16_f32 v32, v56, v57
    v_exp_f32 v64, v64
    s_waitcnt lgkmcnt(5)
    v_mfma_f32_16x16x32_bf16 v[40:43], v[136:139], v[176:179], v[208:211]
    v_exp_f32 v65, v65
    v_mfma_f32_16x16x32_bf16 v[44:47], v[136:139], v[192:195], v[212:215]
    ds_read_b128 v[136:139], v10 offset:36864
    v_cvt_pk_bf16_f32 v33, v58, v59
    v_exp_f32 v66, v66
    s_waitcnt lgkmcnt(5)
    v_mfma_f32_16x16x32_bf16 v[40:43], v[140:143], v[180:183], v[40:43]
    v_exp_f32 v67, v67
    v_mfma_f32_16x16x32_bf16 v[44:47], v[140:143], v[196:199], v[44:47]
    ds_read_b128 v[140:143], v11 offset:36864
    v_cvt_pk_bf16_f32 v34, v64, v65
    v_exp_f32 v60, v60
    s_waitcnt lgkmcnt(5)
    v_mfma_f32_16x16x32_bf16 v[40:43], v[144:147], v[184:187], v[40:43]
    v_exp_f32 v61, v61
    v_mfma_f32_16x16x32_bf16 v[44:47], v[144:147], v[200:203], v[44:47]
    v_cvt_pk_bf16_f32 v35, v66, v67
    v_exp_f32 v62, v62
    s_waitcnt lgkmcnt(4)
    v_mfma_f32_16x16x32_bf16 v[40:43], v[148:151], v[188:191], v[40:43]
    v_exp_f32 v63, v63
    v_mfma_f32_16x16x32_bf16 v[44:47], v[148:151], v[204:207], v[44:47]
    v_cvt_pk_bf16_f32 v36, v60, v61
    v_exp_f32 v68, v68
    s_waitcnt vmcnt(2)
    buffer_load_dwordx4 v5, s[20:23], s79 offen offset:1024 nt lds
    s_waitcnt lgkmcnt(3)
    v_mfma_f32_16x16x32_bf16 v[48:51], v[152:155], v[176:179], v[208:211]
    v_exp_f32 v69, v69
    ds_read_b64_tr_b16 v[160:161], v12 offset:16384
    v_mfma_f32_16x16x32_bf16 v[52:55], v[152:155], v[192:195], v[212:215]
    v_cvt_pk_bf16_f32 v37, v62, v63
    ds_read_b64_tr_b16 v[162:163], v12 offset:20480
    s_waitcnt lgkmcnt(4)
    v_mfma_f32_16x16x32_bf16 v[48:51], v[156:159], v[180:183], v[48:51]
    v_exp_f32 v70, v70
    ds_read_b64_tr_b16 v[164:165], v13 offset:16384
    v_mfma_f32_16x16x32_bf16 v[52:55], v[156:159], v[196:199], v[52:55]
    v_exp_f32 v71, v71
    ds_read_b64_tr_b16 v[166:167], v13 offset:20480
    s_waitcnt lgkmcnt(5)
    v_mfma_f32_16x16x32_bf16 v[48:51], v[136:139], v[184:187], v[48:51]
    v_cvt_pk_bf16_f32 v38, v68, v69
    ds_read_b64_tr_b16 v[168:169], v14 offset:16384
    v_mfma_f32_16x16x32_bf16 v[52:55], v[136:139], v[200:203], v[52:55]
    v_add_f32 v21, v21, v56
    ds_read_b64_tr_b16 v[170:171], v14 offset:20480
    s_waitcnt lgkmcnt(6)
    v_mfma_f32_16x16x32_bf16 v[48:51], v[140:143], v[188:191], v[48:51]
    v_cvt_pk_bf16_f32 v39, v70, v71
    ds_read_b64_tr_b16 v[172:173], v15 offset:16384
    v_mfma_f32_16x16x32_bf16 v[52:55], v[140:143], v[204:207], v[52:55]
    ds_read_b64_tr_b16 v[174:175], v15 offset:20480
    s_waitcnt vmcnt(2)
    buffer_load_dwordx4 v6, s[20:23], s79 offen offset:2048 nt lds
    s_waitcnt lgkmcnt(6)
    v_mfma_f32_16x16x32_bf16 v[72:75], v[160:163], v[32:35], v[72:75]
    v_add_f32 v22, v22, v60
    v_add_f32 v21, v21, v57
    v_mfma_f32_16x16x32_bf16 v[76:79], v[160:163], v[36:39], v[76:79]
    ds_read_b64_tr_b16 v[160:161], v16 offset:16384
    v_add_f32 v22, v22, v61
    ds_read_b64_tr_b16 v[162:163], v16 offset:20480
    s_waitcnt lgkmcnt(6)
    v_mfma_f32_16x16x32_bf16 v[80:83], v[164:167], v[32:35], v[80:83]
    v_add_f32 v21, v21, v58
    v_add_f32 v22, v22, v62
    v_mfma_f32_16x16x32_bf16 v[84:87], v[164:167], v[36:39], v[84:87]
    ds_read_b64_tr_b16 v[164:165], v17 offset:16384
    v_add_f32 v21, v21, v59
    ds_read_b64_tr_b16 v[166:167], v17 offset:20480
    s_waitcnt lgkmcnt(6)
    v_mfma_f32_16x16x32_bf16 v[88:91], v[168:171], v[32:35], v[88:91]
    v_add_f32 v22, v22, v63
    v_add_f32 v21, v21, v64
    v_mfma_f32_16x16x32_bf16 v[92:95], v[168:171], v[36:39], v[92:95]
    ds_read_b64_tr_b16 v[168:169], v18 offset:16384
    v_add_f32 v22, v22, v68
    ds_read_b64_tr_b16 v[170:171], v18 offset:20480
    s_cmp_eq_u32 s77, s96
    s_cbranch_scc1 L_mask7
L_maskb7:
    s_waitcnt lgkmcnt(6)
    v_mfma_f32_16x16x32_bf16 v[96:99], v[172:175], v[32:35], v[96:99]
    v_add_f32 v21, v21, v65
    v_add_f32 v22, v22, v69
    v_mfma_f32_16x16x32_bf16 v[100:103], v[172:175], v[36:39], v[100:103]
    ds_read_b64_tr_b16 v[172:173], v19 offset:16384
    v_add_f32 v21, v21, v66
    ds_read_b64_tr_b16 v[174:175], v19 offset:20480
    s_waitcnt vmcnt(2)
    buffer_load_dwordx4 v7, s[20:23], s79 offen offset:3072 nt lds
    s_waitcnt lgkmcnt(6)
    v_mfma_f32_16x16x32_bf16 v[104:107], v[160:163], v[32:35], v[104:107]
    v_add_f32 v22, v22, v70
    v_add_f32 v21, v21, v67
    v_mfma_f32_16x16x32_bf16 v[108:111], v[160:163], v[36:39], v[108:111]
    v_add_f32 v22, v22, v71
    v_max3_f32 v24, v40, v41, v42
    s_add_u32 s93, s93, 1
    s_add_u32 s75, s75, 1
    s_waitcnt lgkmcnt(4)
    v_mfma_f32_16x16x32_bf16 v[112:115], v[164:167], v[32:35], v[112:115]
    v_max3_f32 v25, v43, v44, v45
    v_max3_f32 v24, v24, v46, v47
    v_mfma_f32_16x16x32_bf16 v[116:119], v[164:167], v[36:39], v[116:119]
    v_max3_f32 v25, v25, v48, v49
    v_max3_f32 v24, v24, v50, v51
    s_add_u32 s77, s77, 1
    s_mov_b32 s97, 8
    s_waitcnt lgkmcnt(2)
    v_mfma_f32_16x16x32_bf16 v[120:123], v[168:171], v[32:35], v[120:123]
    v_max3_f32 v25, v25, v52, v53
    v_max3_f32 v24, v24, v54, v55
    v_mfma_f32_16x16x32_bf16 v[124:127], v[168:171], v[36:39], v[124:127]
    v_max_f32 v24, v24, v25
    v_cmp_lt_f32 vcc, s92, v24
    s_cmp_lg_u32 s84, 0
    s_waitcnt lgkmcnt(0)
    v_mfma_f32_16x16x32_bf16 v[128:131], v[172:175], v[32:35], v[128:131]
    v_mfma_f32_16x16x32_bf16 v[132:135], v[172:175], v[36:39], v[132:135]
    s_cbranch_scc1 L_flush
    s_cbranch_vccnz L_resc0
L_top8:
    s_cmp_eq_u32 s77, s87
    s_cbranch_scc1 L_seg8
L_segb8:
    s_waitcnt vmcnt(4)
    s_barrier
    ds_read_b128 v[136:139], v8 offset:0
    v_readlane_b32 s79, v2, s93
    ds_read_b128 v[140:143], v9 offset:0
    s_mov_b32 m0, s26
    ds_read_b128 v[144:147], v10 offset:0
    s_cmp_lt_u32 s93, s76
    s_cselect_b32 s22, 134348800, 0
    ds_read_b128 v[148:151], v11 offset:0
    v_exp_f32 v40, v40
    v_exp_f32 v41, v41
    ds_read_b128 v[152:155], v8 offset:4096
    v_exp_f32 v42, v42
    v_exp_f32 v43, v43
    ds_read_b128 v[156:159], v9 offset:4096
    s_waitcnt vmcnt(2)
    buffer_load_dwordx4 v4, s[20:23], s79 offen offset:0 nt lds
    v_cvt_pk_bf16_f32 v32, v40, v41
    v_exp_f32 v48, v48
    s_waitcnt lgkmcnt(5)
    v_mfma_f32_16x16x32_bf16 v[56:59], v[136:139], v[176:179], v[208:211]
    v_exp_f32 v49, v49
    v_mfma_f32_16x16x32_bf16 v[60:63], v[136:139], v[192:195], v[212:215]
    ds_read_b128 v[136:139], v10 offset:4096
    v_cvt_pk_bf16_f32 v33, v42, v43
    v_exp_f32 v50, v50
    s_waitcnt lgkmcnt(5)
    v_mfma_f32_16x16x32_bf16 v[56:59], v[140:143], v[180:183], v[56:59]
    v_exp_f32 v51, v51
    v_mfma_f32_16x16x32_bf16 v[60:63], v[140:143], v[196:199], v[60:63]
    ds_read_b128 v[140:143], v11 offset:4096
    v_cvt_pk_bf16_f32 v34, v48, v49
    v_exp_f32 v44, v44
    s_waitcnt lgkmcnt(5)
    v_mfma_f32_16x16x32_bf16 v[56:59], v[144:147], v[184:187], v[56:59]
    v_exp_f32 v45, v45
    v_mfma_f32_16x16x32_bf16 v[60:63], v[144:147], v[200:203], v[60:63]
    v_cvt_pk_bf16_f32 v35, v50, v51
    v_exp_f32 v46, v46
    s_waitcnt lgkmcnt(4)
    v_mfma_f32_16x16x32_bf16 v[56:59], v[148:151], v[188:191], v[56:59]
    v_exp_f32 v47, v47
    v_mfma_f32_16x16x32_bf16 v[60:63], v[148:151], v[204:207], v[60:63]
    v_cvt_pk_bf16_f32 v36, v44, v45
    v_exp_f32 v52, v52
    s_waitcnt vmcnt(2)
    buffer_load_dwordx4 v5, s[20:23], s79 offen offset:1024 nt lds
    s_waitcnt lgkmcnt(3)
    v_mfma_f32_16x16x32_bf16 v[64:67], v[152:155], v[176:179], v[208:211]
    v_exp_f32 v53, v53
    ds_read_b64_tr_b16 v[160:161], v12 offset:32768
    v_mfma_f32_16x16x32_bf16 v[68:71], v[152:155], v[192:195], v[212:215]
    v_cvt_pk_bf16_f32 v37, v46, v47
    ds_read_b64_tr_b16 v[162:163], v12 offset:36864
    s_waitcnt lgkmcnt(4)
    v_mfma_f32_16x16x32_bf16 v[64:67], v[156:159], v[180:183], v[64:67]
    v_exp_f32 v54, v54
    ds_read_b64_tr_b16 v[164:165], v13 offset:32768
    v_mfma_f32_16x16x32_bf16 v[68:71], v[156:159], v[196:199], v[68:71]
    v_exp_f32 v55, v55
    ds_read_b64_tr_b16 v[166:167], v13 offset:36864
    s_waitcnt lgkmcnt(5)
    v_mfma_f32_16x16x32_bf16 v[64:67], v[136:139], v[184:187], v[64:67]
    v_cvt_pk_bf16_f32 v38, v52, v53
    ds_read_b64_tr_b16 v[168:169], v14 offset:32768
    v_mfma_f32_16x16x32_bf16 v[68:71], v[136:139], v[200:203], v[68:71]
    v_add_f32 v21, v21, v40
    ds_read_b64_tr_b16 v[170:171], v14 offset:36864
    s_waitcnt lgkmcnt(6)
    v_mfma_f32_16x16x32_bf16 v[64:67], v[140:143], v[188:191], v[64:67]
    v_cvt_pk_bf16_f32 v39, v54, v55
    ds_read_b64_tr_b16 v[172:173], v15 offset:32768
    v_mfma_f32_16x16x32_bf16 v[68:71], v[140:143], v[204:207], v[68:71]
    ds_read_b64_tr_b16 v[174:175], v15 offset:36864
    s_waitcnt vmcnt(2)
    buffer_load_dwordx4 v6, s[20:23], s79 offen offset:2048 nt lds
    s_waitcnt lgkmcnt(6)
    v_mfma_f32_16x16x32_bf16 v[72:75], v[160:163], v[32:35], v[72:75]
    v_add_f32 v22, v22, v44
    v_add_f32 v21, v21, v41
    v_mfma_f32_16x16x32_bf16 v[76:79], v[160:163], v[36:39], v[76:79]
    ds_read_b64_tr_b16 v[160:161], v16 offset:32768
    v_add_f32 v22, v22, v45
    ds_read_b64_tr_b16 v[162:163], v16 offset:36864
    s_waitcnt lgkmcnt(6)
    v_mfma_f32_16x16x32_bf16 v[80:83], v[164:167], v[32:35], v[80:83]
    v_add_f32 v21, v21, v42
    v_add_f32 v22, v22, v46
    v_mfma_f32_16x16x32_bf16 v[84:87], v[164:167], v[36:39], v[84:87]
    ds_read_b64_tr_b16 v[164:165], v17 offset:32768
    v_add_f32 v21, v21, v43
    ds_read_b64_tr_b16 v[166:167], v17 offset:36864
    s_waitcnt lgkmcnt(6)
    v_mfma_f32_16x16x32_bf16 v[88:91], v[168:171], v[32:35], v[88:91]
    v_add_f32 v22, v22, v47
    v_add_f32 v21, v21, v48
    v_mfma_f32_16x16x32_bf16 v[92:95], v[168:171], v[36:39], v[92:95]
    ds_read_b64_tr_b16 v[168:169], v18 offset:32768
    v_add_f32 v22, v22, v52
    ds_read_b64_tr_b16 v[170:171], v18 offset:36864
    s_cmp_eq_u32 s77, s96
    s_cbranch_scc1 L_mask8
L_maskb8:
    s_waitcnt lgkmcnt(6)
    v_mfma_f32_16x16x32_bf16 v[96:99], v[172:175], v[32:35], v[96:99]
    v_add_f32 v21, v21, v49
    v_add_f32 v22, v22, v53
    v_mfma_f32_16x16x32_bf16 v[100:103], v[172:175], v[36:39], v[100:103]
    ds_read_b64_tr_b16 v[172:173], v19 offset:32768
    v_add_f32 v21, v21, v50
    ds_read_b64_tr_b16 v[174:175], v19 offset:36864
    s_waitcnt vmcnt(2)
    buffer_load_dwordx4 v7, s[20:23], s79 offen offset:3072 nt lds
    s_waitcnt lgkmcnt(6)
    v_mfma_f32_16x16x32_bf16 v[104:107], v[160:163], v[32:35], v[104:107]
    v_add_f32 v22, v22, v54
    v_add_f32 v21, v21, v51
    v_mfma_f32_16x16x32_bf16 v[108:111], v[160:163], v[36:39], v[108:111]
    v_add_f32 v22, v22, v55
    v_max3_f32 v24, v56, v57, v58
    s_add_u32 s93, s93, 1
    s_add_u32 s75, s75, 1
    s_waitcnt lgkmcnt(4)
    v_mfma_f32_16x16x32_bf16 v[112:115], v[164:167], v[32:35], v[112:115]
    v_max3_f32 v25, v59, v60, v61
    v_max3_f32 v24, v24, v62, v63
    v_mfma_f32_16x16x32_bf16 v[116:119], v[164:167], v[36:39], v[116:119]
    v_max3_f32 v25, v25, v64, v65
    v_max3_f32 v24, v24, v66, v67
    s_add_u32 s77, s77, 1
    s_mov_b32 s97, 9
    s_waitcnt lgkmcnt(2)
    v_mfma_f32_16x16x32_bf16 v[120:123], v[168:171], v[32:35], v[120:123]
    v_max3_f32 v25, v25, v68, v69
    v_max3_f32 v24, v24, v70, v71
    v_mfma_f32_16x16x32_bf16 v[124:127], v[168:171], v[36:39], v[124:127]
    v_max_f32 v24, v24, v25
    v_cmp_lt_f32 vcc, s92, v24
    s_cmp_lg_u32 s84, 0
    s_waitcnt lgkmcnt(0)
    v_mfma_f32_16x16x32_bf16 v[128:131], v[172:175], v[32:35], v[128:131]
    v_mfma_f32_16x16x32_bf16 v[132:135], v[172:175], v[36:39], v[132:135]
    s_cbranch_scc1 L_flush
    s_cbranch_vccnz L_resc1
L_top9:
    s_cmp_eq_u32 s77, s87
    s_cbranch_scc1 L_seg9
L_segb9:
    s_waitcnt vmcnt(4)
    s_barrier
    ds_read_b128 v[136:139], v8 offset:16384
    v_readlane_b32 s79, v2, s93
    ds_read_b128 v[140:143], v9 offset:16384
    s_mov_b32 m0, s24
    ds_read_b128 v[144:147], v10 offset:16384
    s_cmp_lt_u32 s93, s76
    s_cselect_b32 s22, 134348800, 0
    ds_read_b128 v[148:151], v11 offset:16384
    v_exp_f32 v56, v56
    v_exp_f32 v57, v57
    ds_read_b128 v[152:155], v8 offset:20480
    v_exp_f32 v58, v58
    v_exp_f32 v59, v59
    ds_read_b128 v[156:159], v9 offset:20480
    s_waitcnt vmcnt(2)
    buffer_load_dwordx4 v4, s[20:23], s79 offen offset:0 nt lds
    v_cvt_pk_bf16_f32 v32, v56, v57
    v_exp_f32 v64, v64
    s_waitcnt lgkmcnt(5)
    v_mfma_f32_16x16x32_bf16 v[40:43], v[136:139], v[176:179], v[208:211]
    v_exp_f32 v65, v65
    v_mfma_f32_16x16x32_bf16 v[44:47], v[136:139], v[192:195], v[212:215]
    ds_read_b128 v[136:139], v10 offset:20480
    v_cvt_pk_bf16_f32 v33, v58, v59
    v_exp_f32 v66, v66
    s_waitcnt lgkmcnt(5)
    v_mfma_f32_16x16x32_bf16 v[40:43], v[140:143], v[180:183], v[40:43]
    v_exp_f32 v67, v67
    v_mfma_f32_16x16x32_bf16 v[44:47], v[140:143], v[196:199], v[44:47]
    ds_read_b128 v[140:143], v11 offset:20480
    v_cvt_pk_bf16_f32 v34, v64, v65
    v_exp_f32 v60, v60
    s_waitcnt lgkmcnt(5)
    v_mfma_f32_16x16x32_bf16 v[40:43], v[144:147], v[184:187], v[40:43]
    v_exp_f32 v61, v61
    v_mfma_f32_16x16x32_bf16 v[44:47], v[144:147], v[200:203], v[44:47]
    v_cvt_pk_bf16_f32 v35, v66, v67
    v_exp_f32 v62, v62
    s_waitcnt lgkmcnt(4)
    v_mfma_f32_16x16x32_bf16 v[40:43], v[148:151], v[188:191], v[40:43]
    v_exp_f32 v63, v63
    v_mfma_f32_16x16x32_bf16 v[44:47], v[148:151], v[204:207], v[44:47]
    v_cvt_pk_bf16_f32 v36, v60, v61
    v_exp_f32 v68, v68
    s_waitcnt vmcnt(2)
    buffer_load_dwordx4 v5, s[20:23], s79 offen offset:1024 nt lds
    s_waitcnt lgkmcnt(3)
    v_mfma_f32_16x16x32_bf16 v[48:51], v[152:155], v[176:179], v[208:211]
    v_exp_f32 v69, v69
    ds_read_b64_tr_b16 v[160:161], v12 offset:0
    v_mfma_f32_16x16x32_bf16 v[52:55], v[152:155], v[192:195], v[212:215]
    v_cvt_pk_bf16_f32 v37, v62, v63
    ds_read_b64_tr_b16 v[162:163], v12 offset:4096
    s_waitcnt lgkmcnt(4)
    v_mfma_f32_16x16x32_bf16 v[48:51], v[156:159], v[180:183], v[48:51]
    v_exp_f32 v70, v70
    ds_read_b64_tr_b16 v[164:165], v13 offset:0
    v_mfma_f32_16x16x32_bf16 v[52:55], v[156:159], v[196:199], v[52:55]
    v_exp_f32 v71, v71
    ds_read_b64_tr_b16 v[166:167], v13 offset:4096
    s_waitcnt lgkmcnt(5)
    v_mfma_f32_16x16x32_bf16 v[48:51], v[136:139], v[184:187], v[48:51]
    v_cvt_pk_bf16_f32 v38, v68, v69
    ds_read_b64_tr_b16 v[168:169], v14 offset:0
    v_mfma_f32_16x16x32_bf16 v[52:55], v[136:139], v[200:203], v[52:55]
    v_add_f32 v21, v21, v56
    ds_read_b64_tr_b16 v[170:171], v14 offset:4096
    s_waitcnt lgkmcnt(6)
    v_mfma_f32_16x16x32_bf16 v[48:51], v[140:143], v[188:191], v[48:51]
    v_cvt_pk_bf16_f32 v39, v70, v71
    ds_read_b64_tr_b16 v[172:173], v15 offset:0
    v_mfma_f32_16x16x32_bf16 v[52:55], v[140:143], v[204:207], v[52:55]
    ds_read_b64_tr_b16 v[174:175], v15 offset:4096
    s_waitcnt vmcnt(2)
    buffer_load_dwordx4 v6, s[20:23], s79 offen offset:2048 nt lds
    s_waitcnt lgkmcnt(6)
    v_mfma_f32_16x16x32_bf16 v[72:75], v[160:163], v[32:35], v[72:75]
    v_add_f32 v22, v22, v60
    v_add_f32 v21, v21, v57
    v_mfma_f32_16x16x32_bf16 v[76:79], v[160:163], v[36:39], v[76:79]
    ds_read_b64_tr_b16 v[160:161], v16 offset:0
    v_add_f32 v22, v22, v61
    ds_read_b64_tr_b16 v[162:163], v16 offset:4096
    s_waitcnt lgkmcnt(6)
    v_mfma_f32_16x16x32_bf16 v[80:83], v[164:167], v[32:35], v[80:83]
    v_add_f32 v21, v21, v58
    v_add_f32 v22, v22, v62
    v_mfma_f32_16x16x32_bf16 v[84:87], v[164:167], v[36:39], v[84:87]
    ds_read_b64_tr_b16 v[164:165], v17 offset:0
    v_add_f32 v21, v21, v59
    ds_read_b64_tr_b16 v[166:167], v17 offset:4096
    s_waitcnt lgkmcnt(6)
    v_mfma_f32_16x16x32_bf16 v[88:91], v[168:171], v[32:35], v[88:91]
    v_add_f32 v22, v22, v63
    v_add_f32 v21, v21, v64
    v_mfma_f32_16x16x32_bf16 v[92:95], v[168:171], v[36:39], v[92:95]
    ds_read_b64_tr_b16 v[168:169], v18 offset:0
    v_add_f32 v22, v22, v68
    ds_read_b64_tr_b16 v[170:171], v18 offset:4096
    s_cmp_eq_u32 s77, s96
    s_cbranch_scc1 L_mask9
L_maskb9:
    s_waitcnt lgkmcnt(6)
    v_mfma_f32_16x16x32_bf16 v[96:99], v[172:175], v[32:35], v[96:99]
    v_add_f32 v21, v21, v65
    v_add_f32 v22, v22, v69
    v_mfma_f32_16x16x32_bf16 v[100:103], v[172:175], v[36:39], v[100:103]
    ds_read_b64_tr_b16 v[172:173], v19 offset:0
    v_add_f32 v21, v21, v66
    ds_read_b64_tr_b16 v[174:175], v19 offset:4096
    s_waitcnt vmcnt(2)
    buffer_load_dwordx4 v7, s[20:23], s79 offen offset:3072 nt lds
    s_waitcnt lgkmcnt(6)
    v_mfma_f32_16x16x32_bf16 v[104:107], v[160:163], v[32:35], v[104:107]
    v_add_f32 v22, v22, v70
    v_add_f32 v21, v21, v67
    v_mfma_f32_16x16x32_bf16 v[108:111], v[160:163], v[36:39], v[108:111]
    v_add_f32 v22, v22, v71
    v_max3_f32 v24, v40, v41, v42
    s_add_u32 s93, s93, 1
    s_add_u32 s75, s75, 1
    s_waitcnt lgkmcnt(4)
    v_mfma_f32_16x16x32_bf16 v[112:115], v[164:167], v[32:35], v[112:115]
    v_max3_f32 v25, v43, v44, v45
    v_max3_f32 v24, v24, v46, v47
    v_mfma_f32_16x16x32_bf16 v[116:119], v[164:167], v[36:39], v[116:119]
    v_max3_f32 v25, v25, v48, v49
    v_max3_f32 v24, v24, v50, v51
    s_add_u32 s77, s77, 1
    s_mov_b32 s97, 10
    s_waitcnt lgkmcnt(2)
    v_mfma_f32_16x16x32_bf16 v[120:123], v[168:171], v[32:35], v[120:123]
    v_max3_f32 v25, v25, v52, v53
    v_max3_f32 v24, v24, v54, v55
    v_mfma_f32_16x16x32_bf16 v[124:127], v[168:171], v[36:39], v[124:127]
    v_max_f32 v24, v24, v25
    v_cmp_lt_f32 vcc, s92, v24
    s_cmp_lg_u32 s84, 0
    s_waitcnt lgkmcnt(0)
    v_mfma_f32_16x16x32_bf16 v[128:131], v[172:175], v[32:35], v[128:131]
    v_mfma_f32_16x16x32_bf16 v[132:135], v[172:175], v[36:39], v[132:135]
    s_cbranch_scc1 L_flush
    s_cbranch_vccnz L_resc0
L_top10:
    s_cmp_eq_u32 s77, s87
    s_cbranch_scc1 L_seg10
L_segb10:
    s_waitcnt vmcnt(4)
    s_barrier
    ds_read_b128 v[136:139], v8 offset:32768
    v_readlane_b32 s79, v2, s93
    ds_read_b128 v[140:143], v9 offset:32768
    s_mov_b32 m0, s25
    ds_read_b128 v[144:147], v10 offset:32768
    s_cmp_lt_u32 s93, s76
    s_cselect_b32 s22, 134348800, 0
    ds_read_b128 v[148:151], v11 offset:32768
    v_exp_f32 v40, v40
    v_exp_f32 v41, v41
    ds_read_b128 v[152:155], v8 offset:36864
    v_exp_f32 v42, v42
    v_exp_f32 v43, v43
    ds_read_b128 v[156:159], v9 offset:36864
    s_waitcnt vmcnt(2)
    buffer_load_dwordx4 v4, s[20:23], s79 offen offset:0 nt lds
    v_cvt_pk_bf16_f32 v32, v40, v41
    v_exp_f32 v48, v48
    s_waitcnt lgkmcnt(5)
    v_mfma_f32_16x16x32_bf16 v[56:59], v[136:139], v[176:179], v[208:211]
    v_exp_f32 v49, v49
    v_mfma_f32_16x16x32_bf16 v[60:63], v[136:139], v[192:195], v[212:215]
    ds_read_b128 v[136:139], v10 offset:36864
    v_cvt_pk_bf16_f32 v33, v42, v43
    v_exp_f32 v50, v50
    s_waitcnt lgkmcnt(5)
    v_mfma_f32_16x16x32_bf16 v[56:59], v[140:143], v[180:183], v[56:59]
    v_exp_f32 v51, v51
    v_mfma_f32_16x16x32_bf16 v[60:63], v[140:143], v[196:199], v[60:63]
    ds_read_b128 v[140:143], v11 offset:36864
    v_cvt_pk_bf16_f32 v34, v48, v49
    v_exp_f32 v44, v44
    s_waitcnt lgkmcnt(5)
    v_mfma_f32_16x16x32_bf16 v[56:59], v[144:147], v[184:187], v[56:59]
    v_exp_f32 v45, v45
    v_mfma_f32_16x16x32_bf16 v[60:63], v[144:147], v[200:203], v[60:63]
    v_cvt_pk_bf16_f32 v35, v50, v51
    v_exp_f32 v46, v46
    s_waitcnt lgkmcnt(4)
    v_mfma_f32_16x16x32_bf16 v[56:59], v[148:151], v[188:191], v[56:59]
    v_exp_f32 v47, v47
    v_mfma_f32_16x16x32_bf16 v[60:63], v[148:151], v[204:207], v[60:63]
    v_cvt_pk_bf16_f32 v36, v44, v45
    v_exp_f32 v52, v52
    s_waitcnt vmcnt(2)
    buffer_load_dwordx4 v5, s[20:23], s79 offen offset:1024 nt lds
    s_waitcnt lgkmcnt(3)
    v_mfma_f32_16x16x32_bf16 v[64:67], v[152:155], v[176:179], v[208:211]
    v_exp_f32 v53, v53
    ds_read_b64_tr_b16 v[160:161], v12 offset:16384
    v_mfma_f32_16x16x32_bf16 v[68:71], v[152:155], v[192:195], v[212:215]
    v_cvt_pk_bf16_f32 v37, v46, v47
    ds_read_b64_tr_b16 v[162:163], v12 offset:20480
    s_waitcnt lgkmcnt(4)
    v_mfma_f32_16x16x32_bf16 v[64:67], v[156:159], v[180:183], v[64:67]
    v_exp_f32 v54, v54
    ds_read_b64_tr_b16 v[164:165], v13 offset:16384
    v_mfma_f32_16x16x32_bf16 v[68:71], v[156:159], v[196:199], v[68:71]
    v_exp_f32 v55, v55
    ds_read_b64_tr_b16 v[166:167], v13 offset:20480
    s_waitcnt lgkmcnt(5)
    v_mfma_f32_16x16x32_bf16 v[64:67], v[136:139], v[184:187], v[64:67]
    v_cvt_pk_bf16_f32 v38, v52, v53
    ds_read_b64_tr_b16 v[168:169], v14 offset:16384
    v_mfma_f32_16x16x32_bf16 v[68:71], v[136:139], v[200:203], v[68:71]
    v_add_f32 v21, v21, v40
    ds_read_b64_tr_b16 v[170:171], v14 offset:20480
    s_waitcnt lgkmcnt(6)
    v_mfma_f32_16x16x32_bf16 v[64:67], v[140:143], v[188:191], v[64:67]
    v_cvt_pk_bf16_f32 v39, v54, v55
    ds_read_b64_tr_b16 v[172:173], v15 offset:16384
    v_mfma_f32_16x16x32_bf16 v[68:71], v[140:143], v[204:207], v[68:71]
    ds_read_b64_tr_b16 v[174:175], v15 offset:20480
    s_waitcnt vmcnt(2)
    buffer_load_dwordx4 v6, s[20:23], s79 offen offset:2048 nt lds
    s_waitcnt lgkmcnt(6)
    v_mfma_f32_16x16x32_bf16 v[72:75], v[160:163], v[32:35], v[72:75]
    v_add_f32 v22, v22, v44
    v_add_f32 v21, v21, v41
    v_mfma_f32_16x16x32_bf16 v[76:79], v[160:163], v[36:39], v[76:79]
    ds_read_b64_tr_b16 v[160:161], v16 offset:16384
    v_add_f32 v22, v22, v45
    ds_read_b64_tr_b16 v[162:163], v16 offset:20480
    s_waitcnt lgkmcnt(6)
    v_mfma_f32_16x16x32_bf16 v[80:83], v[164:167], v[32:35], v[80:83]
    v_add_f32 v21, v21, v42
    v_add_f32 v22, v22, v46
    v_mfma_f32_16x16x32_bf16 v[84:87], v[164:167], v[36:39], v[84:87]
    ds_read_b64_tr_b16 v[164:165], v17 offset:16384
    v_add_f32 v21, v21, v43
    ds_read_b64_tr_b16 v[166:167], v17 offset:20480
    s_waitcnt lgkmcnt(6)
    v_mfma_f32_16x16x32_bf16 v[88:91], v[168:171], v[32:35], v[88:91]
    v_add_f32 v22, v22, v47
    v_add_f32 v21, v21, v48
    v_mfma_f32_16x16x32_bf16 v[92:95], v[168:171], v[36:39], v[92:95]
    ds_read_b64_tr_b16 v[168:169], v18 offset:16384
    v_add_f32 v22, v22, v52
    ds_read_b64_tr_b16 v[170:171], v18 offset:20480
    s_cmp_eq_u32 s77, s96
    s_cbranch_scc1 L_mask10
L_maskb10:
    s_waitcnt lgkmcnt(6)
    v_mfma_f32_16x16x32_bf16 v[96:99], v[172:175], v[32:35], v[96:99]
    v_add_f32 v21, v21, v49
    v_add_f32 v22, v22, v53
    v_mfma_f32_16x16x32_bf16 v[100:103], v[172:175], v[36:39], v[100:103]
    ds_read_b64_tr_b16 v[172:173], v19 offset:16384
    v_add_f32 v21, v21, v50
    ds_read_b64_tr_b16 v[174:175], v19 offset:20480
    s_waitcnt vmcnt(2)
    buffer_load_dwordx4 v7, s[20:23], s79 offen offset:3072 nt lds
    s_waitcnt lgkmcnt(6)
    v_mfma_f32_16x16x32_bf16 v[104:107], v[160:163], v[32:35], v[104:107]
    v_add_f32 v22, v22, v54
    v_add_f32 v21, v21, v51
    v_mfma_f32_16x16x32_bf16 v[108:111], v[160:163], v[36:39], v[108:111]
    v_add_f32 v22, v22, v55
    v_max3_f32 v24, v56, v57, v58
    s_add_u32 s93, s93, 1
    s_add_u32 s75, s75, 1
    s_waitcnt lgkmcnt(4)
    v_mfma_f32_16x16x32_bf16 v[112:115], v[164:167], v[32:35], v[112:115]
    v_max3_f32 v25, v59, v60, v61
    v_max3_f32 v24, v24, v62, v63
    v_mfma_f32_16x16x32_bf16 v[116:119], v[164:167], v[36:39], v[116:119]
    v_max3_f32 v25, v25, v64, v65
    v_max3_f32 v24, v24, v66, v67
    s_add_u32 s77, s77, 1
    s_mov_b32 s97, 11
    s_waitcnt lgkmcnt(2)
    v_mfma_f32_16x16x32_bf16 v[120:123], v[168:171], v[32:35], v[120:123]
    v_max3_f32 v25, v25, v68, v69
    v_max3_f32 v24, v24, v70, v71
    v_mfma_f32_16x16x32_bf16 v[124:127], v[168:171], v[36:39], v[124:127]
    v_max_f32 v24, v24, v25
    v_cmp_lt_f32 vcc, s92, v24
    s_cmp_lg_u32 s84, 0
    s_waitcnt lgkmcnt(0)
    v_mfma_f32_16x16x32_bf16 v[128:131], v[172:175], v[32:35], v[128:131]
    v_mfma_f32_16x16x32_bf16 v[132:135], v[172:175], v[36:39], v[132:135]
    s_cbranch_scc1 L_flush
    s_cbranch_vccnz L_resc1
L_top11:
    s_cmp_eq_u32 s77, s87
    s_cbranch_scc1 L_seg11
L_segb11:
    s_waitcnt vmcnt(4)
    s_barrier
    ds_read_b128 v[136:139], v8 offset:0
    v_readlane_b32 s79, v2, s93
    ds_read_b128 v[140:143], v9 offset:0
    s_mov_b32 m0, s26
    ds_read_b128 v[144:147], v10 offset:0
    s_cmp_lt_u32 s93, s76
    s_cselect_b32 s22, 134348800, 0
    ds_read_b128 v[148:151], v11 offset:0
    v_exp_f32 v56, v56
    v_exp_f32 v57, v57
    ds_read_b128 v[152:155], v8 offset:4096
    v_exp_f32 v58, v58
    v_exp_f32 v59, v59
    ds_read_b128 v[156:159], v9 offset:4096
    s_waitcnt vmcnt(2)
    buffer_load_dwordx4 v4, s[20:23], s79 offen offset:0 nt lds
    v_cvt_pk_bf16_f32 v32, v56, v57
    v_exp_f32 v64, v64
    s_waitcnt lgkmcnt(5)
    v_mfma_f32_16x16x32_bf16 v[40:43], v[136:139], v[176:179], v[208:211]
    v_exp_f32 v65, v65
    v_mfma_f32_16x16x32_bf16 v[44:47], v[136:139], v[192:195], v[212:215]
    ds_read_b128 v[136:139], v10 offset:4096
    v_cvt_pk_bf16_f32 v33, v58, v59
    v_exp_f32 v66, v66
    s_waitcnt lgkmcnt(5)
    v_mfma_f32_16x16x32_bf16 v[40:43], v[140:143], v[180:183], v[40:43]
    v_exp_f32 v67, v67
    v_mfma_f32_16x16x32_bf16 v[44:47], v[140:143], v[196:199], v[44:47]
    ds_read_b128 v[140:143], v11 offset:4096
    v_cvt_pk_bf16_f32 v34, v64, v65
    v_exp_f32 v60, v60
    s_waitcnt lgkmcnt(5)
    v_mfma_f32_16x16x32_bf16 v[40:43], v[144:147], v[184:187], v[40:43]
    v_exp_f32 v61, v61
    v_mfma_f32_16x16x32_bf16 v[44:47], v[144:147], v[200:203], v[44:47]
    v_cvt_pk_bf16_f32 v35, v66, v67
    v_exp_f32 v62, v62
    s_waitcnt lgkmcnt(4)
    v_mfma_f32_16x16x32_bf16 v[40:43], v[148:151], v[188:191], v[40:43]
    v_exp_f32 v63, v63
    v_mfma_f32_16x16x32_bf16 v[44:47], v[148:151], v[204:207], v[44:47]
    v_cvt_pk_bf16_f32 v36, v60, v61
    v_exp_f32 v68, v68
    s_waitcnt vmcnt(2)
    buffer_load_dwordx4 v5, s[20:23], s79 offen offset:1024 nt lds
    s_waitcnt lgkmcnt(3)
    v_mfma_f32_16x16x32_bf16 v[48:51], v[152:155], v[176:179], v[208:211]
    v_exp_f32 v69, v69
    ds_read_b64_tr_b16 v[160:161], v12 offset:32768
    v_mfma_f32_16x16x32_bf16 v[52:55], v[152:155], v[192:195], v[212:215]
    v_cvt_pk_bf16_f32 v37, v62, v63
    ds_read_b64_tr_b16 v[162:163], v12 offset:36864
    s_waitcnt lgkmcnt(4)
    v_mfma_f32_16x16x32_bf16 v[48:51], v[156:159], v[180:183], v[48:51]
    v_exp_f32 v70, v70
    ds_read_b64_tr_b16 v[164:165], v13 offset:32768
    v_mfma_f32_16x16x32_bf16 v[52:55], v[156:159], v[196:199], v[52:55]
    v_exp_f32 v71, v71
    ds_read_b64_tr_b16 v[166:167], v13 offset:36864
    s_waitcnt lgkmcnt(5)
    v_mfma_f32_16x16x32_bf16 v[48:51], v[136:139], v[184:187], v[48:51]
    v_cvt_pk_bf16_f32 v38, v68, v69
    ds_read_b64_tr_b16 v[168:169], v14 offset:32768
    v_mfma_f32_16x16x32_bf16 v[52:55], v[136:139], v[200:203], v[52:55]
    v_add_f32 v21, v21, v56
    ds_read_b64_tr_b16 v[170:171], v14 offset:36864
    s_waitcnt lgkmcnt(6)
    v_mfma_f32_16x16x32_bf16 v[48:51], v[140:143], v[188:191], v[48:51]
    v_cvt_pk_bf16_f32 v39, v70, v71
    ds_read_b64_tr_b16 v[172:173], v15 offset:32768
    v_mfma_f32_16x16x32_bf16 v[52:55], v[140:143], v[204:207], v[52:55]
    ds_read_b64_tr_b16 v[174:175], v15 offset:36864
    s_waitcnt vmcnt(2)
    buffer_load_dwordx4 v6, s[20:23], s79 offen offset:2048 nt lds
    s_waitcnt lgkmcnt(6)
    v_mfma_f32_16x16x32_bf16 v[72:75], v[160:163], v[32:35], v[72:75]
    v_add_f32 v22, v22, v60
    v_add_f32 v21, v21, v57
    v_mfma_f32_16x16x32_bf16 v[76:79], v[160:163], v[36:39], v[76:79]
    ds_read_b64_tr_b16 v[160:161], v16 offset:32768
    v_add_f32 v22, v22, v61
    ds_read_b64_tr_b16 v[162:163], v16 offset:36864
    s_waitcnt lgkmcnt(6)
    v_mfma_f32_16x16x32_bf16 v[80:83], v[164:167], v[32:35], v[80:83]
    v_add_f32 v21, v21, v58
    v_add_f32 v22, v22, v62
    v_mfma_f32_16x16x32_bf16 v[84:87], v[164:167], v[36:39], v[84:87]
    ds_read_b64_tr_b16 v[164:165], v17 offset:32768
    v_add_f32 v21, v21, v59
    ds_read_b64_tr_b16 v[166:167], v17 offset:36864
    s_waitcnt lgkmcnt(6)
    v_mfma_f32_16x16x32_bf16 v[88:91], v[168:171], v[32:35], v[88:91]
    v_add_f32 v22, v22, v63
    v_add_f32 v21, v21, v64
    v_mfma_f32_16x16x32_bf16 v[92:95], v[168:171], v[36:39], v[92:95]
    ds_read_b64_tr_b16 v[168:169], v18 offset:32768
    v_add_f32 v22, v22, v68
    ds_read_b64_tr_b16 v[170:171], v18 offset:36864
    s_cmp_eq_u32 s77, s96
    s_cbranch_scc1 L_mask11
L_maskb11:
    s_waitcnt lgkmcnt(6)
    v_mfma_f32_16x16x32_bf16 v[96:99], v[172:175], v[32:35], v[96:99]
    v_add_f32 v21, v21, v65
    v_add_f32 v22, v22, v69
    v_mfma_f32_16x16x32_bf16 v[100:103], v[172:175], v[36:39], v[100:103]
    ds_read_b64_tr_b16 v[172:173], v19 offset:32768
    v_add_f32 v21, v21, v66
    ds_read_b64_tr_b16 v[174:175], v19 offset:36864
    s_waitcnt vmcnt(2)
    buffer_load_dwordx4 v7, s[20:23], s79 offen offset:3072 nt lds
    s_waitcnt lgkmcnt(6)
    v_mfma_f32_16x16x32_bf16 v[104:107], v[160:163], v[32:35], v[104:107]
    v_add_f32 v22, v22, v70
    v_add_f32 v21, v21, v67
    v_mfma_f32_16x16x32_bf16 v[108:111], v[160:163], v[36:39], v[108:111]
    v_add_f32 v22, v22, v71
    v_max3_f32 v24, v40, v41, v42
    s_add_u32 s93, s93, 1
    s_add_u32 s75, s75, 1
    s_waitcnt lgkmcnt(4)
    v_mfma_f32_16x16x32_bf16 v[112:115], v[164:167], v[32:35], v[112:115]
    v_max3_f32 v25, v43, v44, v45
    v_max3_f32 v24, v24, v46, v47
    v_mfma_f32_16x16x32_bf16 v[116:119], v[164:167], v[36:39], v[116:119]
    v_max3_f32 v25, v25, v48, v49
    v_max3_f32 v24, v24, v50, v51
    s_add_u32 s77, s77, 1
    s_mov_b32 s97, 6
    s_waitcnt lgkmcnt(2)
    v_mfma_f32_16x16x32_bf16 v[120:123], v[168:171], v[32:35], v[120:123]
    v_max3_f32 v25, v25, v52, v53
    v_max3_f32 v24, v24, v54, v55
    v_mfma_f32_16x16x32_bf16 v[124:127], v[168:171], v[36:39], v[124:127]
    v_max_f32 v24, v24, v25
    v_cmp_lt_f32 vcc, s92, v24
    s_cmp_lg_u32 s84, 0
    s_waitcnt lgkmcnt(0)
    v_mfma_f32_16x16x32_bf16 v[128:131], v[172:175], v[32:35], v[128:131]
    v_mfma_f32_16x16x32_bf16 v[132:135], v[172:175], v[36:39], v[132:135]
    s_cbranch_scc1 L_flush
    s_cbranch_vccnz L_resc0
    s_branch L_top6
L_resc0:
    v_max3_f32 v24, v40, v41, v42
    v_max3_f32 v24, v24, v43, v48
    v_max3_f32 v24, v24, v49, v50
    v_max_f32 v24, v24, v51
    v_max3_f32 v25, v44, v45, v46
    v_max3_f32 v25, v25, v47, v52
    v_max3_f32 v25, v25, v53, v54
    v_max_f32 v25, v25, v55
    s_nop 1
    v_permlane32_swap_b32 v24, v25
    v_max_f32 v24, v24, v25
    v_mov_b32 v25, v24
    s_nop 1
    v_permlane16_swap_b32 v24, v25
    v_max_f32 v24, v24, v25
    v_max_f32 v24, 0, v24
    v_exp_f32 v27, -v24
    v_add_f32 v20, v20, v24
    v_mov_b32 v28, v27
    s_nop 1
    v_permlane32_swap_b32 v27, v28
    v_mov_b32 v25, v24
    s_nop 1
    v_permlane32_swap_b32 v24, v25
    v_sub_f32 v208, v208, v24
    v_sub_f32 v209, v209, v24
    v_sub_f32 v210, v210, v24
    v_sub_f32 v211, v211, v24
    v_sub_f32 v40, v40, v24
    v_sub_f32 v41, v41, v24
    v_sub_f32 v42, v42, v24
    v_sub_f32 v43, v43, v24
    v_sub_f32 v48, v48, v24
    v_sub_f32 v49, v49, v24
    v_sub_f32 v50, v50, v24
    v_sub_f32 v51, v51, v24
    v_sub_f32 v212, v212, v25
    v_sub_f32 v213, v213, v25
    v_sub_f32 v214, v214, v25
    v_sub_f32 v215, v215, v25
    v_sub_f32 v44, v44, v25
    v_sub_f32 v45, v45, v25
    v_sub_f32 v46, v46, v25
    v_sub_f32 v47, v47, v25
    v_sub_f32 v52, v52, v25
    v_sub_f32 v53, v53, v25
    v_sub_f32 v54, v54, v25
    v_sub_f32 v55, v55, v25
    v_mul_f32 v21, v21, v27
    v_mul_f32 v22, v22, v28
    v_mul_f32 v72, v72, v27
    v_mul_f32 v73, v73, v27
    v_mul_f32 v74, v74, v27
    v_mul_f32 v75, v75, v27
    v_mul_f32 v76, v76, v28
    v_mul_f32 v77, v77, v28
    v_mul_f32 v78, v78, v28
    v_mul_f32 v79, v79, v28
    v_mul_f32 v80, v80, v27
    v_mul_f32 v81, v81, v27
    v_mul_f32 v82, v82, v27
    v_mul_f32 v83, v83, v27
    v_mul_f32 v84, v84, v28
    v_mul_f32 v85, v85, v28
    v_mul_f32 v86, v86, v28
    v_mul_f32 v87, v87, v28
    v_mul_f32 v88, v88, v27
    v_mul_f32 v89, v89, v27
    v_mul_f32 v90, v90, v27
    v_mul_f32 v91, v91, v27
    v_mul_f32 v92, v92, v28
    v_mul_f32 v93, v93, v28
    v_mul_f32 v94, v94, v28
    v_mul_f32 v95, v95, v28
    v_mul_f32 v96, v96, v27
    v_mul_f32 v97, v97, v27
    v_mul_f32 v98, v98, v27
    v_mul_f32 v99, v99, v27
    v_mul_f32 v100, v100, v28
    v_mul_f32 v101, v101, v28
    v_mul_f32 v102, v102, v28
    v_mul_f32 v103, v103, v28
    v_mul_f32 v104, v104, v27
    v_mul_f32 v105, v105, v27
    v_mul_f32 v106, v106, v27
    v_mul_f32 v107, v107, v27
    v_mul_f32 v108, v108, v28
    v_mul_f32 v109, v109, v28
    v_mul_f32 v110, v110, v28
    v_mul_f32 v111, v111, v28
    v_mul_f32 v112, v112, v27
    v_mul_f32 v113, v113, v27
    v_mul_f32 v114, v114, v27
    v_mul_f32 v115, v115, v27
    v_mul_f32 v116, v116, v28
    v_mul_f32 v117, v117, v28
    v_mul_f32 v118, v118, v28
    v_mul_f32 v119, v119, v28
    v_mul_f32 v120, v120, v27
    v_mul_f32 v121, v121, v27
    v_mul_f32 v122, v122, v27
    v_mul_f32 v123, v123, v27
    v_mul_f32 v124, v124, v28
    v_mul_f32 v125, v125, v28
    v_mul_f32 v126, v126, v28
    v_mul_f32 v127, v127, v28
    v_mul_f32 v128, v128, v27
    v_mul_f32 v129, v129, v27
    v_mul_f32 v130, v130, v27
    v_mul_f32 v131, v131, v27
    v_mul_f32 v132, v132, v28
    v_mul_f32 v133, v133, v28
    v_mul_f32 v134, v134, v28
    v_mul_f32 v135, v135, v28
    s_cmp_eq_u32 s97, 0
    s_cbranch_scc1 L_top0
    s_cmp_eq_u32 s97, 1
    s_cbranch_scc1 L_top1
    s_cmp_eq_u32 s97, 2
    s_cbranch_scc1 L_top2
    s_cmp_eq_u32 s97, 3
    s_cbranch_scc1 L_top3
    s_cmp_eq_u32 s97, 4
    s_cbranch_scc1 L_top4
    s_cmp_eq_u32 s97, 5
    s_cbranch_scc1 L_top5
    s_cmp_eq_u32 s97, 6
    s_cbranch_scc1 L_top6
    s_cmp_eq_u32 s97, 7
    s_cbranch_scc1 L_top7
    s_cmp_eq_u32 s97, 8
    s_cbranch_scc1 L_top8
    s_cmp_eq_u32 s97, 9
    s_cbranch_scc1 L_top9
    s_cmp_eq_u32 s97, 10
    s_cbranch_scc1 L_top10
    s_branch L_top11
L_resc1:
    v_max3_f32 v24, v56, v57, v58
    v_max3_f32 v24, v24, v59, v64
    v_max3_f32 v24, v24, v65, v66
    v_max_f32 v24, v24, v67
    v_max3_f32 v25, v60, v61, v62
    v_max3_f32 v25, v25, v63, v68
    v_max3_f32 v25, v25, v69, v70
    v_max_f32 v25, v25, v71
    s_nop 1
    v_permlane32_swap_b32 v24, v25
    v_max_f32 v24, v24, v25
    v_mov_b32 v25, v24
    s_nop 1
    v_permlane16_swap_b32 v24, v25
    v_max_f32 v24, v24, v25
    v_max_f32 v24, 0, v24
    v_exp_f32 v27, -v24
    v_add_f32 v20, v20, v24
    v_mov_b32 v28, v27
    s_nop 1
    v_permlane32_swap_b32 v27, v28
    v_mov_b32 v25, v24
    s_nop 1
    v_permlane32_swap_b32 v24, v25
    v_sub_f32 v208, v208, v24
    v_sub_f32 v209, v209, v24
    v_sub_f32 v210, v210, v24
    v_sub_f32 v211, v211, v24
    v_sub_f32 v56, v56, v24
    v_sub_f32 v57, v57, v24
    v_sub_f32 v58, v58, v24
    v_sub_f32 v59, v59, v24
    v_sub_f32 v64, v64, v24
    v_sub_f32 v65, v65, v24
    v_sub_f32 v66, v66, v24
    v_sub_f32 v67, v67, v24
    v_sub_f32 v212, v212, v25
    v_sub_f32 v213, v213, v25
    v_sub_f32 v214, v214, v25
    v_sub_f32 v215, v215, v25
    v_sub_f32 v60, v60, v25
    v_sub_f32 v61, v61, v25
    v_sub_f32 v62, v62, v25
    v_sub_f32 v63, v63, v25
    v_sub_f32 v68, v68, v25
    v_sub_f32 v69, v69, v25
    v_sub_f32 v70, v70, v25
    v_sub_f32 v71, v71, v25
    v_mul_f32 v21, v21, v27
    v_mul_f32 v22, v22, v28
    v_mul_f32 v72, v72, v27
    v_mul_f32 v73, v73, v27
    v_mul_f32 v74, v74, v27
    v_mul_f32 v75, v75, v27
    v_mul_f32 v76, v76, v28
    v_mul_f32 v77, v77, v28
    v_mul_f32 v78, v78, v28
    v_mul_f32 v79, v79, v28
    v_mul_f32 v80, v80, v27
    v_mul_f32 v81, v81, v27
    v_mul_f32 v82, v82, v27
    v_mul_f32 v83, v83, v27
    v_mul_f32 v84, v84, v28
    v_mul_f32 v85, v85, v28
    v_mul_f32 v86, v86, v28
    v_mul_f32 v87, v87, v28
    v_mul_f32 v88, v88, v27
    v_mul_f32 v89, v89, v27
    v_mul_f32 v90, v90, v27
    v_mul_f32 v91, v91, v27
    v_mul_f32 v92, v92, v28
    v_mul_f32 v93, v93, v28
    v_mul_f32 v94, v94, v28
    v_mul_f32 v95, v95, v28
    v_mul_f32 v96, v96, v27
    v_mul_f32 v97, v97, v27
    v_mul_f32 v98, v98, v27
    v_mul_f32 v99, v99, v27
    v_mul_f32 v100, v100, v28
    v_mul_f32 v101, v101, v28
    v_mul_f32 v102, v102, v28
    v_mul_f32 v103, v103, v28
    v_mul_f32 v104, v104, v27
    v_mul_f32 v105, v105, v27
    v_mul_f32 v106, v106, v27
    v_mul_f32 v107, v107, v27
    v_mul_f32 v108, v108, v28
    v_mul_f32 v109, v109, v28
    v_mul_f32 v110, v110, v28
    v_mul_f32 v111, v111, v28
    v_mul_f32 v112, v112, v27
    v_mul_f32 v113, v113, v27
    v_mul_f32 v114, v114, v27
    v_mul_f32 v115, v115, v27
    v_mul_f32 v116, v116, v28
    v_mul_f32 v117, v117, v28
    v_mul_f32 v118, v118, v28
    v_mul_f32 v119, v119, v28
    v_mul_f32 v120, v120, v27
    v_mul_f32 v121, v121, v27
    v_mul_f32 v122, v122, v27
    v_mul_f32 v123, v123, v27
    v_mul_f32 v124, v124, v28
    v_mul_f32 v125, v125, v28
    v_mul_f32 v126, v126, v28
    v_mul_f32 v127, v127, v28
    v_mul_f32 v128, v128, v27
    v_mul_f32 v129, v129, v27
    v_mul_f32 v130, v130, v27
    v_mul_f32 v131, v131, v27
    v_mul_f32 v132, v132, v28
    v_mul_f32 v133, v133, v28
    v_mul_f32 v134, v134, v28
    v_mul_f32 v135, v135, v28
    s_cmp_eq_u32 s97, 0
    s_cbranch_scc1 L_top0
    s_cmp_eq_u32 s97, 1
    s_cbranch_scc1 L_top1
    s_cmp_eq_u32 s97, 2
    s_cbranch_scc1 L_top2
    s_cmp_eq_u32 s97, 3
    s_cbranch_scc1 L_top3
    s_cmp_eq_u32 s97, 4
    s_cbranch_scc1 L_top4
    s_cmp_eq_u32 s97, 5
    s_cbranch_scc1 L_top5
    s_cmp_eq_u32 s97, 6
    s_cbranch_scc1 L_top6
    s_cmp_eq_u32 s97, 7
    s_cbranch_scc1 L_top7
    s_cmp_eq_u32 s97, 8
    s_cbranch_scc1 L_top8
    s_cmp_eq_u32 s97, 9
    s_cbranch_scc1 L_top9
    s_cmp_eq_u32 s97, 10
    s_cbranch_scc1 L_top10
    s_branch L_top11
L_flush:
    s_lshl_b32 s89, s69, 13
    s_xor_b32 s88, s89, 0x8000
    s_add_u32 s89, s89, 98304
    s_add_u32 s88, s88, 98304
    v_lshl_add_u32 v26, v1, 4, s89
    v_lshl_add_u32 v27, v1, 4, s88
    s_nop 1
    v_permlane32_swap_b32 v21, v22
    v_add_f32 v21, v21, v22
    v_mov_b32 v22, v21
    s_nop 1
    v_permlane16_swap_b32 v21, v22
    v_add_f32 v21, v21, v22
    v_mov_b32 v136, v23
    v_mov_b32 v137, v21
    ds_write_b64 v26, v[136:137] offset:4096
    v_cvt_pk_bf16_f32 v144, v104, v105
    v_cvt_pk_bf16_f32 v145, v106, v107
    v_cvt_pk_bf16_f32 v146, v108, v109
    v_cvt_pk_bf16_f32 v147, v110, v111
    ds_write_b128 v26, v[144:147] offset:0
    v_cvt_pk_bf16_f32 v148, v112, v113
    v_cvt_pk_bf16_f32 v149, v114, v115
    v_cvt_pk_bf16_f32 v150, v116, v117
    v_cvt_pk_bf16_f32 v151, v118, v119
    ds_write_b128 v26, v[148:151] offset:1024
    v_cvt_pk_bf16_f32 v152, v120, v121
    v_cvt_pk_bf16_f32 v153, v122, v123
    v_cvt_pk_bf16_f32 v154, v124, v125
    v_cvt_pk_bf16_f32 v155, v126, v127
    ds_write_b128 v26, v[152:155] offset:2048
    v_cvt_pk_bf16_f32 v156, v128, v129
    v_cvt_pk_bf16_f32 v157, v130, v131
    v_cvt_pk_bf16_f32 v158, v132, v133
    v_cvt_pk_bf16_f32 v159, v134, v135
    ds_write_b128 v26, v[156:159] offset:3072
    s_mul_i32 s88, s65, 40
    s_add_u32 s88, s88, s66
    s_add_u32 s88, s88, s86
    s_lshl_b32 s89, s88, 9
    s_add_u32 s89, s89, 10485760
    s_lshl_b32 s88, s88, 15
    s_lshl_b32 s91, s78, 7
    v_and_b32 v28, 15, v1
    v_lshrrev_b32 v140, 5, v1
    v_lshl_add_u32 v28, v140, 4, v28
    v_lshl_add_u32 v28, v28, 2, s91
    s_waitcnt lgkmcnt(0)
    s_barrier
    ds_read_b64 v[138:139], v27 offset:4096
    ds_read_b128 v[104:107], v27 offset:0
    ds_read_b128 v[108:111], v27 offset:1024
    ds_read_b128 v[112:115], v27 offset:2048
    ds_read_b128 v[116:119], v27 offset:3072
    s_waitcnt lgkmcnt(4)
    v_max_f32 v24, v136, v138
    v_sub_f32 v136, v136, v24
    v_sub_f32 v138, v138, v24
    v_exp_f32 v136, v136
    v_exp_f32 v138, v138
    s_cmp_lg_u32 s27, 0
    v_mul_f32 v25, v136, v137
    v_fma_f32 v25, v138, v139, v25
    v_rcp_f32 v137, v25
    v_log_f32 v25, v25
    s_nop 0
    v_mul_f32 v136, v136, v137
    v_mul_f32 v138, v138, v137
    v_add_f32 v25, v25, v24
    s_cbranch_scc1 L_nol
    buffer_store_dword v25, v28, s[32:35], s89 offen
L_nol:
    v_mov_b32 v137, v136
    s_nop 1
    v_permlane32_swap_b32 v136, v137
    v_mov_b32 v139, v138
    s_nop 1
    v_permlane32_swap_b32 v138, v139
    v_mul_f32 v72, v72, v136
    v_mul_f32 v73, v73, v136
    v_mul_f32 v74, v74, v136
    v_mul_f32 v75, v75, v136
    v_mul_f32 v76, v76, v137
    v_mul_f32 v77, v77, v137
    v_mul_f32 v78, v78, v137
    v_mul_f32 v79, v79, v137
    s_waitcnt lgkmcnt(3)
    v_lshlrev_b32 v120, 16, v104
    v_and_b32 v121, 0xffff0000, v104
    v_lshlrev_b32 v122, 16, v105
    v_and_b32 v123, 0xffff0000, v105
    v_lshlrev_b32 v124, 16, v106
    v_and_b32 v125, 0xffff0000, v106
    v_lshlrev_b32 v126, 16, v107
    v_and_b32 v127, 0xffff0000, v107
    v_fma_f32 v72, v120, v138, v72
    v_fma_f32 v73, v121, v138, v73
    v_fma_f32 v74, v122, v138, v74
    v_fma_f32 v75, v123, v138, v75
    v_fma_f32 v76, v124, v139, v76
    v_fma_f32 v77, v125, v139, v77
    v_fma_f32 v78, v126, v139, v78
    v_fma_f32 v79, v127, v139, v79
    v_cvt_pk_bf16_f32 v144, v72, v73
    v_cvt_pk_bf16_f32 v145, v74, v75
    v_cvt_pk_bf16_f32 v146, v76, v77
    v_cvt_pk_bf16_f32 v147, v78, v79
    s_nop 0
    v_permlane16_swap_b32 v144, v146
    v_permlane16_swap_b32 v145, v147
    buffer_store_dwordx4 v[144:147], v30, s[32:35], s88 offen offset:0
    v_mul_f32 v80, v80, v136
    v_mul_f32 v81, v81, v136
    v_mul_f32 v82, v82, v136
    v_mul_f32 v83, v83, v136
    v_mul_f32 v84, v84, v137
    v_mul_f32 v85, v85, v137
    v_mul_f32 v86, v86, v137
    v_mul_f32 v87, v87, v137
    s_waitcnt lgkmcnt(2)
    v_lshlrev_b32 v120, 16, v108
    v_and_b32 v121, 0xffff0000, v108
    v_lshlrev_b32 v122, 16, v109
    v_and_b32 v123, 0xffff0000, v109
    v_lshlrev_b32 v124, 16, v110
    v_and_b32 v125, 0xffff0000, v110
    v_lshlrev_b32 v126, 16, v111
    v_and_b32 v127, 0xffff0000, v111
    v_fma_f32 v80, v120, v138, v80
    v_fma_f32 v81, v121, v138, v81
    v_fma_f32 v82, v122, v138, v82
    v_fma_f32 v83, v123, v138, v83
    v_fma_f32 v84, v124, v139, v84
    v_fma_f32 v85, v125, v139, v85
    v_fma_f32 v86, v126, v139, v86
    v_fma_f32 v87, v127, v139, v87
    v_cvt_pk_bf16_f32 v148, v80, v81
    v_cvt_pk_bf16_f32 v149, v82, v83
    v_cvt_pk_bf16_f32 v150, v84, v85
    v_cvt_pk_bf16_f32 v151, v86, v87
    s_nop 0
    v_permlane16_swap_b32 v148, v150
    v_permlane16_swap_b32 v149, v151
    buffer_store_dwordx4 v[148:151], v30, s[32:35], s88 offen offset:1024
    v_mul_f32 v88, v88, v136
    v_mul_f32 v89, v89, v136
    v_mul_f32 v90, v90, v136
    v_mul_f32 v91, v91, v136
    v_mul_f32 v92, v92, v137
    v_mul_f32 v93, v93, v137
    v_mul_f32 v94, v94, v137
    v_mul_f32 v95, v95, v137
    s_waitcnt lgkmcnt(1)
    v_lshlrev_b32 v120, 16, v112
    v_and_b32 v121, 0xffff0000, v112
    v_lshlrev_b32 v122, 16, v113
    v_and_b32 v123, 0xffff0000, v113
    v_lshlrev_b32 v124, 16, v114
    v_and_b32 v125, 0xffff0000, v114
    v_lshlrev_b32 v126, 16, v115
    v_and_b32 v127, 0xffff0000, v115
    v_fma_f32 v88, v120, v138, v88
    v_fma_f32 v89, v121, v138, v89
    v_fma_f32 v90, v122, v138, v90
    v_fma_f32 v91, v123, v138, v91
    v_fma_f32 v92, v124, v139, v92
    v_fma_f32 v93, v125, v139, v93
    v_fma_f32 v94, v126, v139, v94
    v_fma_f32 v95, v127, v139, v95
    v_cvt_pk_bf16_f32 v152, v88, v89
    v_cvt_pk_bf16_f32 v153, v90, v91
    v_cvt_pk_bf16_f32 v154, v92, v93
    v_cvt_pk_bf16_f32 v155, v94, v95
    s_nop 0
    v_permlane16_swap_b32 v152, v154
    v_permlane16_swap_b32 v153, v155
    buffer_store_dwordx4 v[152:155], v30, s[32:35], s88 offen offset:2048
    v_mul_f32 v96, v96, v136
    v_mul_f32 v97, v97, v136
    v_mul_f32 v98, v98, v136
    v_mul_f32 v99, v99, v136
    v_mul_f32 v100, v100, v137
    v_mul_f32 v101, v101, v137
    v_mul_f32 v102, v102, v137
    v_mul_f32 v103, v103, v137
    s_waitcnt lgkmcnt(0)
    v_lshlrev_b32 v120, 16, v116
    v_and_b32 v121, 0xffff0000, v116
    v_lshlrev_b32 v122, 16, v117
    v_and_b32 v123, 0xffff0000, v117
    v_lshlrev_b32 v124, 16, v118
    v_and_b32 v125, 0xffff0000, v118
    v_lshlrev_b32 v126, 16, v119
    v_and_b32 v127, 0xffff0000, v119
    v_fma_f32 v96, v120, v138, v96
    v_fma_f32 v97, v121, v138, v97
    v_fma_f32 v98, v122, v138, v98
    v_fma_f32 v99, v123, v138, v99
    v_fma_f32 v100, v124, v139, v100
    v_fma_f32 v101, v125, v139, v101
    v_fma_f32 v102, v126, v139, v102
    v_fma_f32 v103, v127, v139, v103
    v_cvt_pk_bf16_f32 v156, v96, v97
    v_cvt_pk_bf16_f32 v157, v98, v99
    v_cvt_pk_bf16_f32 v158, v100, v101
    v_cvt_pk_bf16_f32 v159, v102, v103
    s_nop 0
    v_permlane16_swap_b32 v156, v158
    v_permlane16_swap_b32 v157, v159
    buffer_store_dwordx4 v[156:159], v30, s[32:35], s88 offen offset:3072
    s_cmp_ge_u32 s75, s76
    s_cbranch_scc1 L_done
    v_mov_b32 v72, 0
    v_mov_b32 v73, 0
    v_mov_b32 v74, 0
    v_mov_b32 v75, 0
    v_mov_b32 v76, 0
    v_mov_b32 v77, 0
    v_mov_b32 v78, 0
    v_mov_b32 v79, 0
    v_mov_b32 v80, 0
    v_mov_b32 v81, 0
    v_mov_b32 v82, 0
    v_mov_b32 v83, 0
    v_mov_b32 v84, 0
    v_mov_b32 v85, 0
    v_mov_b32 v86, 0
    v_mov_b32 v87, 0
    v_mov_b32 v88, 0
    v_mov_b32 v89, 0
    v_mov_b32 v90, 0
    v_mov_b32 v91, 0
    v_mov_b32 v92, 0
    v_mov_b32 v93, 0
    v_mov_b32 v94, 0
    v_mov_b32 v95, 0
    v_mov_b32 v96, 0
    v_mov_b32 v97, 0
    v_mov_b32 v98, 0
    v_mov_b32 v99, 0
    v_mov_b32 v100, 0
    v_mov_b32 v101, 0
    v_mov_b32 v102, 0
    v_mov_b32 v103, 0
    v_mov_b32 v104, 0
    v_mov_b32 v105, 0
    v_mov_b32 v106, 0
    v_mov_b32 v107, 0
    v_mov_b32 v108, 0
    v_mov_b32 v109, 0
    v_mov_b32 v110, 0
    v_mov_b32 v111, 0
    v_mov_b32 v112, 0
    v_mov_b32 v113, 0
    v_mov_b32 v114, 0
    v_mov_b32 v115, 0
    v_mov_b32 v116, 0
    v_mov_b32 v117, 0
    v_mov_b32 v118, 0
    v_mov_b32 v119, 0
    v_mov_b32 v120, 0
    v_mov_b32 v121, 0
    v_mov_b32 v122, 0
    v_mov_b32 v123, 0
    v_mov_b32 v124, 0
    v_mov_b32 v125, 0
    v_mov_b32 v126, 0
    v_mov_b32 v127, 0
    v_mov_b32 v128, 0
    v_mov_b32 v129, 0
    v_mov_b32 v130, 0
    v_mov_b32 v131, 0
    v_mov_b32 v132, 0
    v_mov_b32 v133, 0
    v_mov_b32 v134, 0
    v_mov_b32 v135, 0
    v_mov_b32 v21, 0
    v_mov_b32 v22, 0
    s_mov_b32 s84, 0
    s_bitcmp1_b32 s97, 0
    s_cbranch_scc1 L_init1
L_init0:
    v_max3_f32 v24, v40, v41, v42
    v_max3_f32 v24, v24, v43, v48
    v_max3_f32 v24, v24, v49, v50
    v_max_f32 v24, v24, v51
    v_max3_f32 v25, v44, v45, v46
    v_max3_f32 v25, v25, v47, v52
    v_max3_f32 v25, v25, v53, v54
    v_max_f32 v25, v25, v55
    s_nop 1
    v_permlane32_swap_b32 v24, v25
    v_max_f32 v24, v24, v25
    v_mov_b32 v25, v24
    s_nop 1
    v_permlane16_swap_b32 v24, v25
    v_max_f32 v24, v24, v25
    v_max_f32 v24, 0xff000000, v24
    v_mov_b32 v20, v24
    v_mov_b32 v25, v24
    s_nop 1
    v_permlane32_swap_b32 v24, v25
    v_sub_f32 v208, 0, v24
    v_sub_f32 v209, 0, v24
    v_sub_f32 v210, 0, v24
    v_sub_f32 v211, 0, v24
    v_sub_f32 v40, v40, v24
    v_sub_f32 v41, v41, v24
    v_sub_f32 v42, v42, v24
    v_sub_f32 v43, v43, v24
    v_sub_f32 v48, v48, v24
    v_sub_f32 v49, v49, v24
    v_sub_f32 v50, v50, v24
    v_sub_f32 v51, v51, v24
    v_sub_f32 v212, 0, v25
    v_sub_f32 v213, 0, v25
    v_sub_f32 v214, 0, v25
    v_sub_f32 v215, 0, v25
    v_sub_f32 v44, v44, v25
    v_sub_f32 v45, v45, v25
    v_sub_f32 v46, v46, v25
    v_sub_f32 v47, v47, v25
    v_sub_f32 v52, v52, v25
    v_sub_f32 v53, v53, v25
    v_sub_f32 v54, v54, v25
    v_sub_f32 v55, v55, v25
    s_cmp_eq_u32 s97, 0
    s_cbranch_scc1 L_top0
    s_cmp_eq_u32 s97, 1
    s_cbranch_scc1 L_top1
    s_cmp_eq_u32 s97, 2
    s_cbranch_scc1 L_top2
    s_cmp_eq_u32 s97, 3
    s_cbranch_scc1 L_top3
    s_cmp_eq_u32 s97, 4
    s_cbranch_scc1 L_top4
    s_cmp_eq_u32 s97, 5
    s_cbranch_scc1 L_top5
    s_cmp_eq_u32 s97, 6
    s_cbranch_scc1 L_top6
    s_cmp_eq_u32 s97, 7
    s_cbranch_scc1 L_top7
    s_cmp_eq_u32 s97, 8
    s_cbranch_scc1 L_top8
    s_cmp_eq_u32 s97, 9
    s_cbranch_scc1 L_top9
    s_cmp_eq_u32 s97, 10
    s_cbranch_scc1 L_top10
    s_branch L_top11
L_init1:
    v_max3_f32 v24, v56, v57, v58
    v_max3_f32 v24, v24, v59, v64
    v_max3_f32 v24, v24, v65, v66
    v_max_f32 v24, v24, v67
    v_max3_f32 v25, v60, v61, v62
    v_max3_f32 v25, v25, v63, v68
    v_max3_f32 v25, v25, v69, v70
    v_max_f32 v25, v25, v71
    s_nop 1
    v_permlane32_swap_b32 v24, v25
    v_max_f32 v24, v24, v25
    v_mov_b32 v25, v24
    s_nop 1
    v_permlane16_swap_b32 v24, v25
    v_max_f32 v24, v24, v25
    v_max_f32 v24, 0xff000000, v24
    v_mov_b32 v20, v24
    v_mov_b32 v25, v24
    s_nop 1
    v_permlane32_swap_b32 v24, v25
    v_sub_f32 v208, 0, v24
    v_sub_f32 v209, 0, v24
    v_sub_f32 v210, 0, v24
    v_sub_f32 v211, 0, v24
    v_sub_f32 v56, v56, v24
    v_sub_f32 v57, v57, v24
    v_sub_f32 v58, v58, v24
    v_sub_f32 v59, v59, v24
    v_sub_f32 v64, v64, v24
    v_sub_f32 v65, v65, v24
    v_sub_f32 v66, v66, v24
    v_sub_f32 v67, v67, v24
    v_sub_f32 v212, 0, v25
    v_sub_f32 v213, 0, v25
    v_sub_f32 v214, 0, v25
    v_sub_f32 v215, 0, v25
    v_sub_f32 v60, v60, v25
    v_sub_f32 v61, v61, v25
    v_sub_f32 v62, v62, v25
    v_sub_f32 v63, v63, v25
    v_sub_f32 v68, v68, v25
    v_sub_f32 v69, v69, v25
    v_sub_f32 v70, v70, v25
    v_sub_f32 v71, v71, v25
    s_cmp_eq_u32 s97, 0
    s_cbranch_scc1 L_top0
    s_cmp_eq_u32 s97, 1
    s_cbranch_scc1 L_top1
    s_cmp_eq_u32 s97, 2
    s_cbranch_scc1 L_top2
    s_cmp_eq_u32 s97, 3
    s_cbranch_scc1 L_top3
    s_cmp_eq_u32 s97, 4
    s_cbranch_scc1 L_top4
    s_cmp_eq_u32 s97, 5
    s_cbranch_scc1 L_top5
    s_cmp_eq_u32 s97, 6
    s_cbranch_scc1 L_top6
    s_cmp_eq_u32 s97, 7
    s_cbranch_scc1 L_top7
    s_cmp_eq_u32 s97, 8
    s_cbranch_scc1 L_top8
    s_cmp_eq_u32 s97, 9
    s_cbranch_scc1 L_top9
    s_cmp_eq_u32 s97, 10
    s_cbranch_scc1 L_top10
    s_branch L_top11
L_done:
L_exit:
    s_endpgm
L_empty:
    s_cmp_lg_u32 s2, 0
    s_cbranch_scc1 L_exit
    v_mov_b32 v33, v32
    v_lshlrev_b32 v34, 2, v1
    v_add_u32 v35, 4, v34
    ds_bpermute_b32 v33, v35, v32
    s_waitcnt lgkmcnt(0)
    v_max_u32 v36, s56, v32
    v_min_u32 v37, s57, v33
    v_cmp_lt_u32 vcc, v36, v37
    s_nop 3
    v_writelane_b32 v35, vcc_lo, 0
    v_max_u32 v36, s57, v32
    v_min_u32 v37, s58, v33
    v_cmp_lt_u32 vcc, v36, v37
    s_nop 3
    v_writelane_b32 v35, vcc_lo, 1
    v_max_u32 v36, s58, v32
    v_min_u32 v37, s59, v33
    v_cmp_lt_u32 vcc, v36, v37
    s_nop 3
    v_writelane_b32 v35, vcc_lo, 2
    v_max_u32 v36, s59, v32
    v_min_u32 v37, s60, v33
    v_cmp_lt_u32 vcc, v36, v37
    s_nop 3
    v_writelane_b32 v35, vcc_lo, 3
    v_max_u32 v36, s60, v32
    v_min_u32 v37, s61, v33
    v_cmp_lt_u32 vcc, v36, v37
    s_nop 3
    v_writelane_b32 v35, vcc_lo, 4
    v_max_u32 v36, s61, v32
    v_min_u32 v37, s62, v33
    v_cmp_lt_u32 vcc, v36, v37
    s_nop 3
    v_writelane_b32 v35, vcc_lo, 5
    v_max_u32 v36, s62, v32
    v_min_u32 v37, s63, v33
    v_cmp_lt_u32 vcc, v36, v37
    s_nop 3
    v_writelane_b32 v35, vcc_lo, 6
    v_max_u32 v36, s63, v32
    v_min_u32 v37, s64, v33
    v_cmp_lt_u32 vcc, v36, v37
    s_nop 3
    v_writelane_b32 v35, vcc_lo, 7
    s_mov_b32 s88, 10649600
    s_mov_b64 exec, 0xff
    buffer_store_dword v35, v34, s[32:35], s88 offen
    s_mov_b64 exec, -1
    s_endpgm
L_seg0:
    s_mov_b32 s97, 0
    s_branch L_seg
L_seg1:
    s_mov_b32 s97, 1
    s_branch L_seg
L_seg2:
    s_mov_b32 s97, 2
    s_branch L_seg
L_seg3:
    s_mov_b32 s97, 3
    s_branch L_seg
L_seg4:
    s_mov_b32 s97, 4
    s_branch L_seg
L_seg5:
    s_mov_b32 s97, 5
    s_branch L_seg
L_seg6:
    s_mov_b32 s97, 6
    s_branch L_seg
L_seg7:
    s_mov_b32 s97, 7
    s_branch L_seg
L_seg8:
    s_mov_b32 s97, 8
    s_branch L_seg
L_seg9:
    s_mov_b32 s97, 9
    s_branch L_seg
L_seg10:
    s_mov_b32 s97, 10
    s_branch L_seg
L_seg11:
    s_mov_b32 s97, 11
L_seg:
    s_mov_b32 s86, s70
    s_mov_b32 s84, 1
    v_mov_b32 v23, v20
    s_cmp_eq_u32 s77, s68
    s_cbranch_scc1 L_tail
    s_add_u32 s70, s70, 1
    s_cmp_eq_u32 s85, 0
    s_cbranch_scc1 L_segld
    s_cmp_ge_u32 s75, 2
    s_cbranch_scc1 L_segrd
    s_branch L_segwt
L_segld:
    s_barrier
    s_lshl_b32 s88, s70, 3
    s_add_u32 s88, s88, s65
    s_lshl_b32 s88, s88, 3
    s_add_u32 s88, s88, s69
    s_lshl_b32 s88, s88, 12
    s_lshl_b32 s89, s69, 12
    s_add_u32 m0, s89, 98304
    v_xor_b32 v161, 64, v29
    v_xor_b32 v162, 128, v29
    v_xor_b32 v163, 192, v29
    buffer_load_dwordx4 v29, s[28:31], s88 offen offset:0 lds
    buffer_load_dwordx4 v161, s[28:31], s88 offen offset:1024 lds
    buffer_load_dwordx4 v162, s[28:31], s88 offen offset:2048 lds
    buffer_load_dwordx4 v163, s[28:31], s88 offen offset:3072 lds
L_segwt:
    s_waitcnt vmcnt(0)
    s_barrier
L_segrd:
    s_sub_u32 s88, s78, s27
    s_lshl_b32 s88, s88, 13
    s_add_u32 s88, s88, 98304
    v_add_u32 v164, s88, v8
    v_add_u32 v165, s88, v9
    v_add_u32 v166, s88, v10
    v_add_u32 v167, s88, v11
    ds_read_b128 v[176:179], v164 offset:0
    ds_read_b128 v[180:183], v165 offset:0
    ds_read_b128 v[184:187], v166 offset:0
    ds_read_b128 v[188:191], v167 offset:0
    ds_read_b128 v[192:195], v164 offset:4096
    ds_read_b128 v[196:199], v165 offset:4096
    ds_read_b128 v[200:203], v166 offset:4096
    ds_read_b128 v[204:207], v167 offset:4096
    s_mov_b32 s85, 0
    v_readlane_b32 s88, v3, s70
    s_nop 3
    s_cmp_lt_i32 s88, 1
    s_cselect_b32 s73, 0, 0x3e0293ee
    s_cselect_b32 s88, 0x2000, s88
    s_min_u32 s72, s88, 0x2000
    s_add_u32 s88, s72, 63
    s_lshr_b32 s88, s88, 6
    s_add_u32 s71, s71, s88
    s_sub_u32 s88, s71, 1
    s_and_b32 s89, s72, 63
    s_cselect_b32 s96, s88, -1
    s_min_u32 s87, s71, s68
    v_mov_b32 v208, 0
    v_mov_b32 v209, 0
    v_mov_b32 v210, 0
    v_mov_b32 v211, 0
    v_mov_b32 v212, 0
    v_mov_b32 v213, 0
    v_mov_b32 v214, 0
    v_mov_b32 v215, 0
    v_mov_b32 v160, s73
    v_mov_b32 v161, s73
    s_waitcnt lgkmcnt(7)
    v_lshlrev_b32 v168, 16, v176
    v_and_b32 v169, 0xffff0000, v176
    v_lshlrev_b32 v170, 16, v177
    v_and_b32 v171, 0xffff0000, v177
    v_lshlrev_b32 v172, 16, v178
    v_and_b32 v173, 0xffff0000, v178
    v_lshlrev_b32 v174, 16, v179
    v_and_b32 v175, 0xffff0000, v179
    v_pk_mul_f32 v[168:169], v[168:169], v[160:161]
    v_pk_mul_f32 v[170:171], v[170:171], v[160:161]
    v_pk_mul_f32 v[172:173], v[172:173], v[160:161]
    v_pk_mul_f32 v[174:175], v[174:175], v[160:161]
    v_cvt_pk_bf16_f32 v176, v168, v169
    v_cvt_pk_bf16_f32 v177, v170, v171
    v_cvt_pk_bf16_f32 v178, v172, v173
    v_cvt_pk_bf16_f32 v179, v174, v175
    s_waitcnt lgkmcnt(6)
    v_lshlrev_b32 v168, 16, v180
    v_and_b32 v169, 0xffff0000, v180
    v_lshlrev_b32 v170, 16, v181
    v_and_b32 v171, 0xffff0000, v181
    v_lshlrev_b32 v172, 16, v182
    v_and_b32 v173, 0xffff0000, v182
    v_lshlrev_b32 v174, 16, v183
    v_and_b32 v175, 0xffff0000, v183
    v_pk_mul_f32 v[168:169], v[168:169], v[160:161]
    v_pk_mul_f32 v[170:171], v[170:171], v[160:161]
    v_pk_mul_f32 v[172:173], v[172:173], v[160:161]
    v_pk_mul_f32 v[174:175], v[174:175], v[160:161]
    v_cvt_pk_bf16_f32 v180, v168, v169
    v_cvt_pk_bf16_f32 v181, v170, v171
    v_cvt_pk_bf16_f32 v182, v172, v173
    v_cvt_pk_bf16_f32 v183, v174, v175
    s_waitcnt lgkmcnt(5)
    v_lshlrev_b32 v168, 16, v184
    v_and_b32 v169, 0xffff0000, v184
    v_lshlrev_b32 v170, 16, v185
    v_and_b32 v171, 0xffff0000, v185
    v_lshlrev_b32 v172, 16, v186
    v_and_b32 v173, 0xffff0000, v186
    v_lshlrev_b32 v174, 16, v187
    v_and_b32 v175, 0xffff0000, v187
    v_pk_mul_f32 v[168:169], v[168:169], v[160:161]
    v_pk_mul_f32 v[170:171], v[170:171], v[160:161]
    v_pk_mul_f32 v[172:173], v[172:173], v[160:161]
    v_pk_mul_f32 v[174:175], v[174:175], v[160:161]
    v_cvt_pk_bf16_f32 v184, v168, v169
    v_cvt_pk_bf16_f32 v185, v170, v171
    v_cvt_pk_bf16_f32 v186, v172, v173
    v_cvt_pk_bf16_f32 v187, v174, v175
    s_waitcnt lgkmcnt(4)
    v_lshlrev_b32 v168, 16, v188
    v_and_b32 v169, 0xffff0000, v188
    v_lshlrev_b32 v170, 16, v189
    v_and_b32 v171, 0xffff0000, v189
    v_lshlrev_b32 v172, 16, v190
    v_and_b32 v173, 0xffff0000, v190
    v_lshlrev_b32 v174, 16, v191
    v_and_b32 v175, 0xffff0000, v191
    v_pk_mul_f32 v[168:169], v[168:169], v[160:161]
    v_pk_mul_f32 v[170:171], v[170:171], v[160:161]
    v_pk_mul_f32 v[172:173], v[172:173], v[160:161]
    v_pk_mul_f32 v[174:175], v[174:175], v[160:161]
    v_cvt_pk_bf16_f32 v188, v168, v169
    v_cvt_pk_bf16_f32 v189, v170, v171
    v_cvt_pk_bf16_f32 v190, v172, v173
    v_cvt_pk_bf16_f32 v191, v174, v175
    s_waitcnt lgkmcnt(3)
    v_lshlrev_b32 v168, 16, v192
    v_and_b32 v169, 0xffff0000, v192
    v_lshlrev_b32 v170, 16, v193
    v_and_b32 v171, 0xffff0000, v193
    v_lshlrev_b32 v172, 16, v194
    v_and_b32 v173, 0xffff0000, v194
    v_lshlrev_b32 v174, 16, v195
    v_and_b32 v175, 0xffff0000, v195
    v_pk_mul_f32 v[168:169], v[168:169], v[160:161]
    v_pk_mul_f32 v[170:171], v[170:171], v[160:161]
    v_pk_mul_f32 v[172:173], v[172:173], v[160:161]
    v_pk_mul_f32 v[174:175], v[174:175], v[160:161]
    v_cvt_pk_bf16_f32 v192, v168, v169
    v_cvt_pk_bf16_f32 v193, v170, v171
    v_cvt_pk_bf16_f32 v194, v172, v173
    v_cvt_pk_bf16_f32 v195, v174, v175
    s_waitcnt lgkmcnt(2)
    v_lshlrev_b32 v168, 16, v196
    v_and_b32 v169, 0xffff0000, v196
    v_lshlrev_b32 v170, 16, v197
    v_and_b32 v171, 0xffff0000, v197
    v_lshlrev_b32 v172, 16, v198
    v_and_b32 v173, 0xffff0000, v198
    v_lshlrev_b32 v174, 16, v199
    v_and_b32 v175, 0xffff0000, v199
    v_pk_mul_f32 v[168:169], v[168:169], v[160:161]
    v_pk_mul_f32 v[170:171], v[170:171], v[160:161]
    v_pk_mul_f32 v[172:173], v[172:173], v[160:161]
    v_pk_mul_f32 v[174:175], v[174:175], v[160:161]
    v_cvt_pk_bf16_f32 v196, v168, v169
    v_cvt_pk_bf16_f32 v197, v170, v171
    v_cvt_pk_bf16_f32 v198, v172, v173
    v_cvt_pk_bf16_f32 v199, v174, v175
    s_waitcnt lgkmcnt(1)
    v_lshlrev_b32 v168, 16, v200
    v_and_b32 v169, 0xffff0000, v200
    v_lshlrev_b32 v170, 16, v201
    v_and_b32 v171, 0xffff0000, v201
    v_lshlrev_b32 v172, 16, v202
    v_and_b32 v173, 0xffff0000, v202
    v_lshlrev_b32 v174, 16, v203
    v_and_b32 v175, 0xffff0000, v203
    v_pk_mul_f32 v[168:169], v[168:169], v[160:161]
    v_pk_mul_f32 v[170:171], v[170:171], v[160:161]
    v_pk_mul_f32 v[172:173], v[172:173], v[160:161]
    v_pk_mul_f32 v[174:175], v[174:175], v[160:161]
    v_cvt_pk_bf16_f32 v200, v168, v169
    v_cvt_pk_bf16_f32 v201, v170, v171
    v_cvt_pk_bf16_f32 v202, v172, v173
    v_cvt_pk_bf16_f32 v203, v174, v175
    s_waitcnt lgkmcnt(0)
    v_lshlrev_b32 v168, 16, v204
    v_and_b32 v169, 0xffff0000, v204
    v_lshlrev_b32 v170, 16, v205
    v_and_b32 v171, 0xffff0000, v205
    v_lshlrev_b32 v172, 16, v206
    v_and_b32 v173, 0xffff0000, v206
    v_lshlrev_b32 v174, 16, v207
    v_and_b32 v175, 0xffff0000, v207
    v_pk_mul_f32 v[168:169], v[168:169], v[160:161]
    v_pk_mul_f32 v[170:171], v[170:171], v[160:161]
    v_pk_mul_f32 v[172:173], v[172:173], v[160:161]
    v_pk_mul_f32 v[174:175], v[174:175], v[160:161]
    v_cvt_pk_bf16_f32 v204, v168, v169
    v_cvt_pk_bf16_f32 v205, v170, v171
    v_cvt_pk_bf16_f32 v206, v172, v173
    v_cvt_pk_bf16_f32 v207, v174, v175
L_segr:
    s_cmp_eq_u32 s97, 0
    s_cbranch_scc1 L_segb0
    s_cmp_eq_u32 s97, 1
    s_cbranch_scc1 L_segb1
    s_cmp_eq_u32 s97, 2
    s_cbranch_scc1 L_segb2
    s_cmp_eq_u32 s97, 3
    s_cbranch_scc1 L_segb3
    s_cmp_eq_u32 s97, 4
    s_cbranch_scc1 L_segb4
    s_cmp_eq_u32 s97, 5
    s_cbranch_scc1 L_segb5
    s_cmp_eq_u32 s97, 6
    s_cbranch_scc1 L_segb6
    s_cmp_eq_u32 s97, 7
    s_cbranch_scc1 L_segb7
    s_cmp_eq_u32 s97, 8
    s_cbranch_scc1 L_segb8
    s_cmp_eq_u32 s97, 9
    s_cbranch_scc1 L_segb9
    s_cmp_eq_u32 s97, 10
    s_cbranch_scc1 L_segb10
    s_branch L_segb11
L_tail:
    s_mov_b32 s75, s76
    s_sub_u32 s88, s97, 6
    s_cselect_b32 s97, s97, s88
    s_cmp_eq_u32 s97, 0
    s_cbranch_scc1 L_tail0
    s_cmp_eq_u32 s97, 1
    s_cbranch_scc1 L_tail1
    s_cmp_eq_u32 s97, 2
    s_cbranch_scc1 L_tail2
    s_cmp_eq_u32 s97, 3
    s_cbranch_scc1 L_tail3
    s_cmp_eq_u32 s97, 4
    s_cbranch_scc1 L_tail4
    s_branch L_tail5
L_tail0:
    v_exp_f32 v40, v40
    v_exp_f32 v41, v41
    v_exp_f32 v42, v42
    v_exp_f32 v43, v43
    v_cvt_pk_bf16_f32 v32, v40, v41
    v_exp_f32 v48, v48
    v_exp_f32 v49, v49
    v_cvt_pk_bf16_f32 v33, v42, v43
    v_exp_f32 v50, v50
    v_exp_f32 v51, v51
    v_cvt_pk_bf16_f32 v34, v48, v49
    v_exp_f32 v44, v44
    v_exp_f32 v45, v45
    v_cvt_pk_bf16_f32 v35, v50, v51
    v_exp_f32 v46, v46
    v_exp_f32 v47, v47
    v_cvt_pk_bf16_f32 v36, v44, v45
    v_exp_f32 v52, v52
    v_exp_f32 v53, v53
    v_cvt_pk_bf16_f32 v37, v46, v47
    v_exp_f32 v54, v54
    v_exp_f32 v55, v55
    v_cvt_pk_bf16_f32 v38, v52, v53
    v_add_f32 v21, v21, v40
    v_cvt_pk_bf16_f32 v39, v54, v55
    s_waitcnt vmcnt(4)
    s_barrier
    ds_read_b64_tr_b16 v[160:161], v12 offset:0
    ds_read_b64_tr_b16 v[162:163], v12 offset:4096
    ds_read_b64_tr_b16 v[164:165], v13 offset:0
    ds_read_b64_tr_b16 v[166:167], v13 offset:4096
    ds_read_b64_tr_b16 v[168:169], v14 offset:0
    ds_read_b64_tr_b16 v[170:171], v14 offset:4096
    ds_read_b64_tr_b16 v[172:173], v15 offset:0
    ds_read_b64_tr_b16 v[174:175], v15 offset:4096
    ds_read_b64_tr_b16 v[136:137], v16 offset:0
    ds_read_b64_tr_b16 v[138:139], v16 offset:4096
    ds_read_b64_tr_b16 v[140:141], v17 offset:0
    ds_read_b64_tr_b16 v[142:143], v17 offset:4096
    ds_read_b64_tr_b16 v[144:145], v18 offset:0
    ds_read_b64_tr_b16 v[146:147], v18 offset:4096
    ds_read_b64_tr_b16 v[148:149], v19 offset:0
    ds_read_b64_tr_b16 v[150:151], v19 offset:4096
    v_add_f32 v22, v22, v44
    v_add_f32 v21, v21, v41
    v_add_f32 v22, v22, v45
    v_add_f32 v21, v21, v42
    v_add_f32 v22, v22, v46
    v_add_f32 v21, v21, v43
    v_add_f32 v22, v22, v47
    v_add_f32 v21, v21, v48
    v_add_f32 v22, v22, v52
    v_add_f32 v21, v21, v49
    v_add_f32 v22, v22, v53
    v_add_f32 v21, v21, v50
    v_add_f32 v22, v22, v54
    v_add_f32 v21, v21, v51
    v_add_f32 v22, v22, v55
    s_waitcnt lgkmcnt(14)
    v_mfma_f32_16x16x32_bf16 v[72:75], v[160:163], v[32:35], v[72:75]
    v_mfma_f32_16x16x32_bf16 v[76:79], v[160:163], v[36:39], v[76:79]
    s_waitcnt lgkmcnt(12)
    v_mfma_f32_16x16x32_bf16 v[80:83], v[164:167], v[32:35], v[80:83]
    v_mfma_f32_16x16x32_bf16 v[84:87], v[164:167], v[36:39], v[84:87]
    s_waitcnt lgkmcnt(10)
    v_mfma_f32_16x16x32_bf16 v[88:91], v[168:171], v[32:35], v[88:91]
    v_mfma_f32_16x16x32_bf16 v[92:95], v[168:171], v[36:39], v[92:95]
    s_waitcnt lgkmcnt(8)
    v_mfma_f32_16x16x32_bf16 v[96:99], v[172:175], v[32:35], v[96:99]
    v_mfma_f32_16x16x32_bf16 v[100:103], v[172:175], v[36:39], v[100:103]
    s_waitcnt lgkmcnt(6)
    v_mfma_f32_16x16x32_bf16 v[104:107], v[136:139], v[32:35], v[104:107]
    v_mfma_f32_16x16x32_bf16 v[108:111], v[136:139], v[36:39], v[108:111]
    s_waitcnt lgkmcnt(4)
    v_mfma_f32_16x16x32_bf16 v[112:115], v[140:143], v[32:35], v[112:115]
    v_mfma_f32_16x16x32_bf16 v[116:119], v[140:143], v[36:39], v[116:119]
    s_waitcnt lgkmcnt(2)
    v_mfma_f32_16x16x32_bf16 v[120:123], v[144:147], v[32:35], v[120:123]
    v_mfma_f32_16x16x32_bf16 v[124:127], v[144:147], v[36:39], v[124:127]
    s_waitcnt lgkmcnt(0)
    v_mfma_f32_16x16x32_bf16 v[128:131], v[148:151], v[32:35], v[128:131]
    v_mfma_f32_16x16x32_bf16 v[132:135], v[148:151], v[36:39], v[132:135]
    s_branch L_flush
L_tail1:
    v_exp_f32 v56, v56
    v_exp_f32 v57, v57
    v_exp_f32 v58, v58
    v_exp_f32 v59, v59
    v_cvt_pk_bf16_f32 v32, v56, v57
    v_exp_f32 v64, v64
    v_exp_f32 v65, v65
    v_cvt_pk_bf16_f32 v33, v58, v59
    v_exp_f32 v66, v66
    v_exp_f32 v67, v67
    v_cvt_pk_bf16_f32 v34, v64, v65
    v_exp_f32 v60, v60
    v_exp_f32 v61, v61
    v_cvt_pk_bf16_f32 v35, v66, v67
    v_exp_f32 v62, v62
    v_exp_f32 v63, v63
    v_cvt_pk_bf16_f32 v36, v60, v61
    v_exp_f32 v68, v68
    v_exp_f32 v69, v69
    v_cvt_pk_bf16_f32 v37, v62, v63
    v_exp_f32 v70, v70
    v_exp_f32 v71, v71
    v_cvt_pk_bf16_f32 v38, v68, v69
    v_add_f32 v21, v21, v56
    v_cvt_pk_bf16_f32 v39, v70, v71
    s_waitcnt vmcnt(4)
    s_barrier
    ds_read_b64_tr_b16 v[160:161], v12 offset:16384
    ds_read_b64_tr_b16 v[162:163], v12 offset:20480
    ds_read_b64_tr_b16 v[164:165], v13 offset:16384
    ds_read_b64_tr_b16 v[166:167], v13 offset:20480
    ds_read_b64_tr_b16 v[168:169], v14 offset:16384
    ds_read_b64_tr_b16 v[170:171], v14 offset:20480
    ds_read_b64_tr_b16 v[172:173], v15 offset:16384
    ds_read_b64_tr_b16 v[174:175], v15 offset:20480
    ds_read_b64_tr_b16 v[136:137], v16 offset:16384
    ds_read_b64_tr_b16 v[138:139], v16 offset:20480
    ds_read_b64_tr_b16 v[140:141], v17 offset:16384
    ds_read_b64_tr_b16 v[142:143], v17 offset:20480
    ds_read_b64_tr_b16 v[144:145], v18 offset:16384
    ds_read_b64_tr_b16 v[146:147], v18 offset:20480
    ds_read_b64_tr_b16 v[148:149], v19 offset:16384
    ds_read_b64_tr_b16 v[150:151], v19 offset:20480
    v_add_f32 v22, v22, v60
    v_add_f32 v21, v21, v57
    v_add_f32 v22, v22, v61
    v_add_f32 v21, v21, v58
    v_add_f32 v22, v22, v62
    v_add_f32 v21, v21, v59
    v_add_f32 v22, v22, v63
    v_add_f32 v21, v21, v64
    v_add_f32 v22, v22, v68
    v_add_f32 v21, v21, v65
    v_add_f32 v22, v22, v69
    v_add_f32 v21, v21, v66
    v_add_f32 v22, v22, v70
    v_add_f32 v21, v21, v67
    v_add_f32 v22, v22, v71
    s_waitcnt lgkmcnt(14)
    v_mfma_f32_16x16x32_bf16 v[72:75], v[160:163], v[32:35], v[72:75]
    v_mfma_f32_16x16x32_bf16 v[76:79], v[160:163], v[36:39], v[76:79]
    s_waitcnt lgkmcnt(12)
    v_mfma_f32_16x16x32_bf16 v[80:83], v[164:167], v[32:35], v[80:83]
    v_mfma_f32_16x16x32_bf16 v[84:87], v[164:167], v[36:39], v[84:87]
    s_waitcnt lgkmcnt(10)
    v_mfma_f32_16x16x32_bf16 v[88:91], v[168:171], v[32:35], v[88:91]
    v_mfma_f32_16x16x32_bf16 v[92:95], v[168:171], v[36:39], v[92:95]
    s_waitcnt lgkmcnt(8)
    v_mfma_f32_16x16x32_bf16 v[96:99], v[172:175], v[32:35], v[96:99]
    v_mfma_f32_16x16x32_bf16 v[100:103], v[172:175], v[36:39], v[100:103]
    s_waitcnt lgkmcnt(6)
    v_mfma_f32_16x16x32_bf16 v[104:107], v[136:139], v[32:35], v[104:107]
    v_mfma_f32_16x16x32_bf16 v[108:111], v[136:139], v[36:39], v[108:111]
    s_waitcnt lgkmcnt(4)
    v_mfma_f32_16x16x32_bf16 v[112:115], v[140:143], v[32:35], v[112:115]
    v_mfma_f32_16x16x32_bf16 v[116:119], v[140:143], v[36:39], v[116:119]
    s_waitcnt lgkmcnt(2)
    v_mfma_f32_16x16x32_bf16 v[120:123], v[144:147], v[32:35], v[120:123]
    v_mfma_f32_16x16x32_bf16 v[124:127], v[144:147], v[36:39], v[124:127]
    s_waitcnt lgkmcnt(0)
    v_mfma_f32_16x16x32_bf16 v[128:131], v[148:151], v[32:35], v[128:131]
    v_mfma_f32_16x16x32_bf16 v[132:135], v[148:151], v[36:39], v[132:135]
    s_branch L_flush
L_tail2:
    v_exp_f32 v40, v40
    v_exp_f32 v41, v41
    v_exp_f32 v42, v42
    v_exp_f32 v43, v43
    v_cvt_pk_bf16_f32 v32, v40, v41
    v_exp_f32 v48, v48
    v_exp_f32 v49, v49
    v_cvt_pk_bf16_f32 v33, v42, v43
    v_exp_f32 v50, v50
    v_exp_f32 v51, v51
    v_cvt_pk_bf16_f32 v34, v48, v49
    v_exp_f32 v44, v44
    v_exp_f32 v45, v45
    v_cvt_pk_bf16_f32 v35, v50, v51
    v_exp_f32 v46, v46
    v_exp_f32 v47, v47
    v_cvt_pk_bf16_f32 v36, v44, v45
    v_exp_f32 v52, v52
    v_exp_f32 v53, v53
    v_cvt_pk_bf16_f32 v37, v46, v47
    v_exp_f32 v54, v54
    v_exp_f32 v55, v55
    v_cvt_pk_bf16_f32 v38, v52, v53
    v_add_f32 v21, v21, v40
    v_cvt_pk_bf16_f32 v39, v54, v55
    s_waitcnt vmcnt(4)
    s_barrier
    ds_read_b64_tr_b16 v[160:161], v12 offset:32768
    ds_read_b64_tr_b16 v[162:163], v12 offset:36864
    ds_read_b64_tr_b16 v[164:165], v13 offset:32768
    ds_read_b64_tr_b16 v[166:167], v13 offset:36864
    ds_read_b64_tr_b16 v[168:169], v14 offset:32768
    ds_read_b64_tr_b16 v[170:171], v14 offset:36864
    ds_read_b64_tr_b16 v[172:173], v15 offset:32768
    ds_read_b64_tr_b16 v[174:175], v15 offset:36864
    ds_read_b64_tr_b16 v[136:137], v16 offset:32768
    ds_read_b64_tr_b16 v[138:139], v16 offset:36864
    ds_read_b64_tr_b16 v[140:141], v17 offset:32768
    ds_read_b64_tr_b16 v[142:143], v17 offset:36864
    ds_read_b64_tr_b16 v[144:145], v18 offset:32768
    ds_read_b64_tr_b16 v[146:147], v18 offset:36864
    ds_read_b64_tr_b16 v[148:149], v19 offset:32768
    ds_read_b64_tr_b16 v[150:151], v19 offset:36864
    v_add_f32 v22, v22, v44
    v_add_f32 v21, v21, v41
    v_add_f32 v22, v22, v45
    v_add_f32 v21, v21, v42
    v_add_f32 v22, v22, v46
    v_add_f32 v21, v21, v43
    v_add_f32 v22, v22, v47
    v_add_f32 v21, v21, v48
    v_add_f32 v22, v22, v52
    v_add_f32 v21, v21, v49
    v_add_f32 v22, v22, v53
    v_add_f32 v21, v21, v50
    v_add_f32 v22, v22, v54
    v_add_f32 v21, v21, v51
    v_add_f32 v22, v22, v55
    s_waitcnt lgkmcnt(14)
    v_mfma_f32_16x16x32_bf16 v[72:75], v[160:163], v[32:35], v[72:75]
    v_mfma_f32_16x16x32_bf16 v[76:79], v[160:163], v[36:39], v[76:79]
    s_waitcnt lgkmcnt(12)
    v_mfma_f32_16x16x32_bf16 v[80:83], v[164:167], v[32:35], v[80:83]
    v_mfma_f32_16x16x32_bf16 v[84:87], v[164:167], v[36:39], v[84:87]
    s_waitcnt lgkmcnt(10)
    v_mfma_f32_16x16x32_bf16 v[88:91], v[168:171], v[32:35], v[88:91]
    v_mfma_f32_16x16x32_bf16 v[92:95], v[168:171], v[36:39], v[92:95]
    s_waitcnt lgkmcnt(8)
    v_mfma_f32_16x16x32_bf16 v[96:99], v[172:175], v[32:35], v[96:99]
    v_mfma_f32_16x16x32_bf16 v[100:103], v[172:175], v[36:39], v[100:103]
    s_waitcnt lgkmcnt(6)
    v_mfma_f32_16x16x32_bf16 v[104:107], v[136:139], v[32:35], v[104:107]
    v_mfma_f32_16x16x32_bf16 v[108:111], v[136:139], v[36:39], v[108:111]
    s_waitcnt lgkmcnt(4)
    v_mfma_f32_16x16x32_bf16 v[112:115], v[140:143], v[32:35], v[112:115]
    v_mfma_f32_16x16x32_bf16 v[116:119], v[140:143], v[36:39], v[116:119]
    s_waitcnt lgkmcnt(2)
    v_mfma_f32_16x16x32_bf16 v[120:123], v[144:147], v[32:35], v[120:123]
    v_mfma_f32_16x16x32_bf16 v[124:127], v[144:147], v[36:39], v[124:127]
    s_waitcnt lgkmcnt(0)
    v_mfma_f32_16x16x32_bf16 v[128:131], v[148:151], v[32:35], v[128:131]
    v_mfma_f32_16x16x32_bf16 v[132:135], v[148:151], v[36:39], v[132:135]
    s_branch L_flush
L_tail3:
    v_exp_f32 v56, v56
    v_exp_f32 v57, v57
    v_exp_f32 v58, v58
    v_exp_f32 v59, v59
    v_cvt_pk_bf16_f32 v32, v56, v57
    v_exp_f32 v64, v64
    v_exp_f32 v65, v65
    v_cvt_pk_bf16_f32 v33, v58, v59
    v_exp_f32 v66, v66
    v_exp_f32 v67, v67
    v_cvt_pk_bf16_f32 v34, v64, v65
    v_exp_f32 v60, v60
    v_exp_f32 v61, v61
    v_cvt_pk_bf16_f32 v35, v66, v67
    v_exp_f32 v62, v62
    v_exp_f32 v63, v63
    v_cvt_pk_bf16_f32 v36, v60, v61
    v_exp_f32 v68, v68
    v_exp_f32 v69, v69
    v_cvt_pk_bf16_f32 v37, v62, v63
    v_exp_f32 v70, v70
    v_exp_f32 v71, v71
    v_cvt_pk_bf16_f32 v38, v68, v69
    v_add_f32 v21, v21, v56
    v_cvt_pk_bf16_f32 v39, v70, v71
    s_waitcnt vmcnt(4)
    s_barrier
    ds_read_b64_tr_b16 v[160:161], v12 offset:0
    ds_read_b64_tr_b16 v[162:163], v12 offset:4096
    ds_read_b64_tr_b16 v[164:165], v13 offset:0
    ds_read_b64_tr_b16 v[166:167], v13 offset:4096
    ds_read_b64_tr_b16 v[168:169], v14 offset:0
    ds_read_b64_tr_b16 v[170:171], v14 offset:4096
    ds_read_b64_tr_b16 v[172:173], v15 offset:0
    ds_read_b64_tr_b16 v[174:175], v15 offset:4096
    ds_read_b64_tr_b16 v[136:137], v16 offset:0
    ds_read_b64_tr_b16 v[138:139], v16 offset:4096
    ds_read_b64_tr_b16 v[140:141], v17 offset:0
    ds_read_b64_tr_b16 v[142:143], v17 offset:4096
    ds_read_b64_tr_b16 v[144:145], v18 offset:0
    ds_read_b64_tr_b16 v[146:147], v18 offset:4096
    ds_read_b64_tr_b16 v[148:149], v19 offset:0
    ds_read_b64_tr_b16 v[150:151], v19 offset:4096
    v_add_f32 v22, v22, v60
    v_add_f32 v21, v21, v57
    v_add_f32 v22, v22, v61
    v_add_f32 v21, v21, v58
    v_add_f32 v22, v22, v62
    v_add_f32 v21, v21, v59
    v_add_f32 v22, v22, v63
    v_add_f32 v21, v21, v64
    v_add_f32 v22, v22, v68
    v_add_f32 v21, v21, v65
    v_add_f32 v22, v22, v69
    v_add_f32 v21, v21, v66
    v_add_f32 v22, v22, v70
    v_add_f32 v21, v21, v67
    v_add_f32 v22, v22, v71
    s_waitcnt lgkmcnt(14)
    v_mfma_f32_16x16x32_bf16 v[72:75], v[160:163], v[32:35], v[72:75]
    v_mfma_f32_16x16x32_bf16 v[76:79], v[160:163], v[36:39], v[76:79]
    s_waitcnt lgkmcnt(12)
    v_mfma_f32_16x16x32_bf16 v[80:83], v[164:167], v[32:35], v[80:83]
    v_mfma_f32_16x16x32_bf16 v[84:87], v[164:167], v[36:39], v[84:87]
    s_waitcnt lgkmcnt(10)
    v_mfma_f32_16x16x32_bf16 v[88:91], v[168:171], v[32:35], v[88:91]
    v_mfma_f32_16x16x32_bf16 v[92:95], v[168:171], v[36:39], v[92:95]
    s_waitcnt lgkmcnt(8)
    v_mfma_f32_16x16x32_bf16 v[96:99], v[172:175], v[32:35], v[96:99]
    v_mfma_f32_16x16x32_bf16 v[100:103], v[172:175], v[36:39], v[100:103]
    s_waitcnt lgkmcnt(6)
    v_mfma_f32_16x16x32_bf16 v[104:107], v[136:139], v[32:35], v[104:107]
    v_mfma_f32_16x16x32_bf16 v[108:111], v[136:139], v[36:39], v[108:111]
    s_waitcnt lgkmcnt(4)
    v_mfma_f32_16x16x32_bf16 v[112:115], v[140:143], v[32:35], v[112:115]
    v_mfma_f32_16x16x32_bf16 v[116:119], v[140:143], v[36:39], v[116:119]
    s_waitcnt lgkmcnt(2)
    v_mfma_f32_16x16x32_bf16 v[120:123], v[144:147], v[32:35], v[120:123]
    v_mfma_f32_16x16x32_bf16 v[124:127], v[144:147], v[36:39], v[124:127]
    s_waitcnt lgkmcnt(0)
    v_mfma_f32_16x16x32_bf16 v[128:131], v[148:151], v[32:35], v[128:131]
    v_mfma_f32_16x16x32_bf16 v[132:135], v[148:151], v[36:39], v[132:135]
    s_branch L_flush
L_tail4:
    v_exp_f32 v40, v40
    v_exp_f32 v41, v41
    v_exp_f32 v42, v42
    v_exp_f32 v43, v43
    v_cvt_pk_bf16_f32 v32, v40, v41
    v_exp_f32 v48, v48
    v_exp_f32 v49, v49
    v_cvt_pk_bf16_f32 v33, v42, v43
    v_exp_f32 v50, v50
    v_exp_f32 v51, v51
    v_cvt_pk_bf16_f32 v34, v48, v49
    v_exp_f32 v44, v44
    v_exp_f32 v45, v45
    v_cvt_pk_bf16_f32 v35, v50, v51
    v_exp_f32 v46, v46
    v_exp_f32 v47, v47
    v_cvt_pk_bf16_f32 v36, v44, v45
    v_exp_f32 v52, v52
    v_exp_f32 v53, v53
    v_cvt_pk_bf16_f32 v37, v46, v47
    v_exp_f32 v54, v54
    v_exp_f32 v55, v55
    v_cvt_pk_bf16_f32 v38, v52, v53
    v_add_f32 v21, v21, v40
    v_cvt_pk_bf16_f32 v39, v54, v55
    s_waitcnt vmcnt(4)
    s_barrier
    ds_read_b64_tr_b16 v[160:161], v12 offset:16384
    ds_read_b64_tr_b16 v[162:163], v12 offset:20480
    ds_read_b64_tr_b16 v[164:165], v13 offset:16384
    ds_read_b64_tr_b16 v[166:167], v13 offset:20480
    ds_read_b64_tr_b16 v[168:169], v14 offset:16384
    ds_read_b64_tr_b16 v[170:171], v14 offset:20480
    ds_read_b64_tr_b16 v[172:173], v15 offset:16384
    ds_read_b64_tr_b16 v[174:175], v15 offset:20480
    ds_read_b64_tr_b16 v[136:137], v16 offset:16384
    ds_read_b64_tr_b16 v[138:139], v16 offset:20480
    ds_read_b64_tr_b16 v[140:141], v17 offset:16384
    ds_read_b64_tr_b16 v[142:143], v17 offset:20480
    ds_read_b64_tr_b16 v[144:145], v18 offset:16384
    ds_read_b64_tr_b16 v[146:147], v18 offset:20480
    ds_read_b64_tr_b16 v[148:149], v19 offset:16384
    ds_read_b64_tr_b16 v[150:151], v19 offset:20480
    v_add_f32 v22, v22, v44
    v_add_f32 v21, v21, v41
    v_add_f32 v22, v22, v45
    v_add_f32 v21, v21, v42
    v_add_f32 v22, v22, v46
    v_add_f32 v21, v21, v43
    v_add_f32 v22, v22, v47
    v_add_f32 v21, v21, v48
    v_add_f32 v22, v22, v52
    v_add_f32 v21, v21, v49
    v_add_f32 v22, v22, v53
    v_add_f32 v21, v21, v50
    v_add_f32 v22, v22, v54
    v_add_f32 v21, v21, v51
    v_add_f32 v22, v22, v55
    s_waitcnt lgkmcnt(14)
    v_mfma_f32_16x16x32_bf16 v[72:75], v[160:163], v[32:35], v[72:75]
    v_mfma_f32_16x16x32_bf16 v[76:79], v[160:163], v[36:39], v[76:79]
    s_waitcnt lgkmcnt(12)
    v_mfma_f32_16x16x32_bf16 v[80:83], v[164:167], v[32:35], v[80:83]
    v_mfma_f32_16x16x32_bf16 v[84:87], v[164:167], v[36:39], v[84:87]
    s_waitcnt lgkmcnt(10)
    v_mfma_f32_16x16x32_bf16 v[88:91], v[168:171], v[32:35], v[88:91]
    v_mfma_f32_16x16x32_bf16 v[92:95], v[168:171], v[36:39], v[92:95]
    s_waitcnt lgkmcnt(8)
    v_mfma_f32_16x16x32_bf16 v[96:99], v[172:175], v[32:35], v[96:99]
    v_mfma_f32_16x16x32_bf16 v[100:103], v[172:175], v[36:39], v[100:103]
    s_waitcnt lgkmcnt(6)
    v_mfma_f32_16x16x32_bf16 v[104:107], v[136:139], v[32:35], v[104:107]
    v_mfma_f32_16x16x32_bf16 v[108:111], v[136:139], v[36:39], v[108:111]
    s_waitcnt lgkmcnt(4)
    v_mfma_f32_16x16x32_bf16 v[112:115], v[140:143], v[32:35], v[112:115]
    v_mfma_f32_16x16x32_bf16 v[116:119], v[140:143], v[36:39], v[116:119]
    s_waitcnt lgkmcnt(2)
    v_mfma_f32_16x16x32_bf16 v[120:123], v[144:147], v[32:35], v[120:123]
    v_mfma_f32_16x16x32_bf16 v[124:127], v[144:147], v[36:39], v[124:127]
    s_waitcnt lgkmcnt(0)
    v_mfma_f32_16x16x32_bf16 v[128:131], v[148:151], v[32:35], v[128:131]
    v_mfma_f32_16x16x32_bf16 v[132:135], v[148:151], v[36:39], v[132:135]
    s_branch L_flush
L_tail5:
    v_exp_f32 v56, v56
    v_exp_f32 v57, v57
    v_exp_f32 v58, v58
    v_exp_f32 v59, v59
    v_cvt_pk_bf16_f32 v32, v56, v57
    v_exp_f32 v64, v64
    v_exp_f32 v65, v65
    v_cvt_pk_bf16_f32 v33, v58, v59
    v_exp_f32 v66, v66
    v_exp_f32 v67, v67
    v_cvt_pk_bf16_f32 v34, v64, v65
    v_exp_f32 v60, v60
    v_exp_f32 v61, v61
    v_cvt_pk_bf16_f32 v35, v66, v67
    v_exp_f32 v62, v62
    v_exp_f32 v63, v63
    v_cvt_pk_bf16_f32 v36, v60, v61
    v_exp_f32 v68, v68
    v_exp_f32 v69, v69
    v_cvt_pk_bf16_f32 v37, v62, v63
    v_exp_f32 v70, v70
    v_exp_f32 v71, v71
    v_cvt_pk_bf16_f32 v38, v68, v69
    v_add_f32 v21, v21, v56
    v_cvt_pk_bf16_f32 v39, v70, v71
    s_waitcnt vmcnt(4)
    s_barrier
    ds_read_b64_tr_b16 v[160:161], v12 offset:32768
    ds_read_b64_tr_b16 v[162:163], v12 offset:36864
    ds_read_b64_tr_b16 v[164:165], v13 offset:32768
    ds_read_b64_tr_b16 v[166:167], v13 offset:36864
    ds_read_b64_tr_b16 v[168:169], v14 offset:32768
    ds_read_b64_tr_b16 v[170:171], v14 offset:36864
    ds_read_b64_tr_b16 v[172:173], v15 offset:32768
    ds_read_b64_tr_b16 v[174:175], v15 offset:36864
    ds_read_b64_tr_b16 v[136:137], v16 offset:32768
    ds_read_b64_tr_b16 v[138:139], v16 offset:36864
    ds_read_b64_tr_b16 v[140:141], v17 offset:32768
    ds_read_b64_tr_b16 v[142:143], v17 offset:36864
    ds_read_b64_tr_b16 v[144:145], v18 offset:32768
    ds_read_b64_tr_b16 v[146:147], v18 offset:36864
    ds_read_b64_tr_b16 v[148:149], v19 offset:32768
    ds_read_b64_tr_b16 v[150:151], v19 offset:36864
    v_add_f32 v22, v22, v60
    v_add_f32 v21, v21, v57
    v_add_f32 v22, v22, v61
    v_add_f32 v21, v21, v58
    v_add_f32 v22, v22, v62
    v_add_f32 v21, v21, v59
    v_add_f32 v22, v22, v63
    v_add_f32 v21, v21, v64
    v_add_f32 v22, v22, v68
    v_add_f32 v21, v21, v65
    v_add_f32 v22, v22, v69
    v_add_f32 v21, v21, v66
    v_add_f32 v22, v22, v70
    v_add_f32 v21, v21, v67
    v_add_f32 v22, v22, v71
    s_waitcnt lgkmcnt(14)
    v_mfma_f32_16x16x32_bf16 v[72:75], v[160:163], v[32:35], v[72:75]
    v_mfma_f32_16x16x32_bf16 v[76:79], v[160:163], v[36:39], v[76:79]
    s_waitcnt lgkmcnt(12)
    v_mfma_f32_16x16x32_bf16 v[80:83], v[164:167], v[32:35], v[80:83]
    v_mfma_f32_16x16x32_bf16 v[84:87], v[164:167], v[36:39], v[84:87]
    s_waitcnt lgkmcnt(10)
    v_mfma_f32_16x16x32_bf16 v[88:91], v[168:171], v[32:35], v[88:91]
    v_mfma_f32_16x16x32_bf16 v[92:95], v[168:171], v[36:39], v[92:95]
    s_waitcnt lgkmcnt(8)
    v_mfma_f32_16x16x32_bf16 v[96:99], v[172:175], v[32:35], v[96:99]
    v_mfma_f32_16x16x32_bf16 v[100:103], v[172:175], v[36:39], v[100:103]
    s_waitcnt lgkmcnt(6)
    v_mfma_f32_16x16x32_bf16 v[104:107], v[136:139], v[32:35], v[104:107]
    v_mfma_f32_16x16x32_bf16 v[108:111], v[136:139], v[36:39], v[108:111]
    s_waitcnt lgkmcnt(4)
    v_mfma_f32_16x16x32_bf16 v[112:115], v[140:143], v[32:35], v[112:115]
    v_mfma_f32_16x16x32_bf16 v[116:119], v[140:143], v[36:39], v[116:119]
    s_waitcnt lgkmcnt(2)
    v_mfma_f32_16x16x32_bf16 v[120:123], v[144:147], v[32:35], v[120:123]
    v_mfma_f32_16x16x32_bf16 v[124:127], v[144:147], v[36:39], v[124:127]
    s_waitcnt lgkmcnt(0)
    v_mfma_f32_16x16x32_bf16 v[128:131], v[148:151], v[32:35], v[128:131]
    v_mfma_f32_16x16x32_bf16 v[132:135], v[148:151], v[36:39], v[132:135]
    s_branch L_flush
L_mask0:
    s_mov_b32 s97, 0
    s_branch L_maskc0
L_mask2:
    s_mov_b32 s97, 2
    s_branch L_maskc0
L_mask4:
    s_mov_b32 s97, 4
    s_branch L_maskc0
L_mask6:
    s_mov_b32 s97, 6
    s_branch L_maskc0
L_mask8:
    s_mov_b32 s97, 8
    s_branch L_maskc0
L_mask10:
    s_mov_b32 s97, 10
L_maskc0:
    s_and_b32 s88, s72, 63
    s_lshl_b32 s89, s27, 5
    s_sub_i32 s88, s88, s89
    v_lshrrev_b32 v26, 4, v1
    v_lshlrev_b32 v26, 2, v26
    v_sub_u32 v26, s88, v26
    v_mov_b32 v25, 0xff800000
    s_nop 7
    v_cmp_lt_i32 vcc, 0, v26
    v_cmp_gt_i32 s[90:91], v26, 1
    s_nop 0
    v_cndmask_b32 v56, v25, v56, vcc
    v_cndmask_b32 v57, v25, v57, s[90:91]
    v_cndmask_b32 v60, v25, v60, vcc
    v_cndmask_b32 v61, v25, v61, s[90:91]
    v_cmp_lt_i32 vcc, 2, v26
    v_cmp_gt_i32 s[90:91], v26, 3
    s_nop 0
    v_cndmask_b32 v58, v25, v58, vcc
    v_cndmask_b32 v59, v25, v59, s[90:91]
    v_cndmask_b32 v62, v25, v62, vcc
    v_cndmask_b32 v63, v25, v63, s[90:91]
    v_cmp_lt_i32 vcc, 16, v26
    v_cmp_gt_i32 s[90:91], v26, 17
    s_nop 0
    v_cndmask_b32 v64, v25, v64, vcc
    v_cndmask_b32 v65, v25, v65, s[90:91]
    v_cndmask_b32 v68, v25, v68, vcc
    v_cndmask_b32 v69, v25, v69, s[90:91]
    v_cmp_lt_i32 vcc, 18, v26
    v_cmp_gt_i32 s[90:91], v26, 19
    s_nop 0
    v_cndmask_b32 v66, v25, v66, vcc
    v_cndmask_b32 v67, v25, v67, s[90:91]
    v_cndmask_b32 v70, v25, v70, vcc
    v_cndmask_b32 v71, v25, v71, s[90:91]
    s_cmp_eq_u32 s97, 0
    s_cbranch_scc1 L_maskb0
    s_cmp_eq_u32 s97, 1
    s_cbranch_scc1 L_maskb1
    s_cmp_eq_u32 s97, 2
    s_cbranch_scc1 L_maskb2
    s_cmp_eq_u32 s97, 3
    s_cbranch_scc1 L_maskb3
    s_cmp_eq_u32 s97, 4
    s_cbranch_scc1 L_maskb4
    s_cmp_eq_u32 s97, 5
    s_cbranch_scc1 L_maskb5
    s_cmp_eq_u32 s97, 6
    s_cbranch_scc1 L_maskb6
    s_cmp_eq_u32 s97, 7
    s_cbranch_scc1 L_maskb7
    s_cmp_eq_u32 s97, 8
    s_cbranch_scc1 L_maskb8
    s_cmp_eq_u32 s97, 9
    s_cbranch_scc1 L_maskb9
    s_cmp_eq_u32 s97, 10
    s_cbranch_scc1 L_maskb10
    s_branch L_maskb11
L_mask1:
    s_mov_b32 s97, 1
    s_branch L_maskc1
L_mask3:
    s_mov_b32 s97, 3
    s_branch L_maskc1
L_mask5:
    s_mov_b32 s97, 5
    s_branch L_maskc1
L_mask7:
    s_mov_b32 s97, 7
    s_branch L_maskc1
L_mask9:
    s_mov_b32 s97, 9
    s_branch L_maskc1
L_mask11:
    s_mov_b32 s97, 11
L_maskc1:
    s_and_b32 s88, s72, 63
    s_lshl_b32 s89, s27, 5
    s_sub_i32 s88, s88, s89
    v_lshrrev_b32 v26, 4, v1
    v_lshlrev_b32 v26, 2, v26
    v_sub_u32 v26, s88, v26
    v_mov_b32 v25, 0xff800000
    s_nop 7
    v_cmp_lt_i32 vcc, 0, v26
    v_cmp_gt_i32 s[90:91], v26, 1
    s_nop 0
    v_cndmask_b32 v40, v25, v40, vcc
    v_cndmask_b32 v41, v25, v41, s[90:91]
    v_cndmask_b32 v44, v25, v44, vcc
    v_cndmask_b32 v45, v25, v45, s[90:91]
    v_cmp_lt_i32 vcc, 2, v26
    v_cmp_gt_i32 s[90:91], v26, 3
    s_nop 0
    v_cndmask_b32 v42, v25, v42, vcc
    v_cndmask_b32 v43, v25, v43, s[90:91]
    v_cndmask_b32 v46, v25, v46, vcc
    v_cndmask_b32 v47, v25, v47, s[90:91]
    v_cmp_lt_i32 vcc, 16, v26
    v_cmp_gt_i32 s[90:91], v26, 17
    s_nop 0
    v_cndmask_b32 v48, v25, v48, vcc
    v_cndmask_b32 v49, v25, v49, s[90:91]
    v_cndmask_b32 v52, v25, v52, vcc
    v_cndmask_b32 v53, v25, v53, s[90:91]
    v_cmp_lt_i32 vcc, 18, v26
    v_cmp_gt_i32 s[90:91], v26, 19
    s_nop 0
    v_cndmask_b32 v50, v25, v50, vcc
    v_cndmask_b32 v51, v25, v51, s[90:91]
    v_cndmask_b32 v54, v25, v54, vcc
    v_cndmask_b32 v55, v25, v55, s[90:91]
    s_cmp_eq_u32 s97, 0
    s_cbranch_scc1 L_maskb0
    s_cmp_eq_u32 s97, 1
    s_cbranch_scc1 L_maskb1
    s_cmp_eq_u32 s97, 2
    s_cbranch_scc1 L_maskb2
    s_cmp_eq_u32 s97, 3
    s_cbranch_scc1 L_maskb3
    s_cmp_eq_u32 s97, 4
    s_cbranch_scc1 L_maskb4
    s_cmp_eq_u32 s97, 5
    s_cbranch_scc1 L_maskb5
    s_cmp_eq_u32 s97, 6
    s_cbranch_scc1 L_maskb6
    s_cmp_eq_u32 s97, 7
    s_cbranch_scc1 L_maskb7
    s_cmp_eq_u32 s97, 8
    s_cbranch_scc1 L_maskb8
    s_cmp_eq_u32 s97, 9
    s_cbranch_scc1 L_maskb9
    s_cmp_eq_u32 s97, 10
    s_cbranch_scc1 L_maskb10
    s_branch L_maskb11
.globl combine_kernel
.p2align 8
.type combine_kernel,@function
combine_kernel:
    s_cmp_ge_u32 s2, 256
    s_cbranch_scc1 C_exit
    s_load_dwordx8 s[12:19], s[0:1], 32
    s_lshr_b32 s70, s2, 5
    s_bfe_u32 s69, s2, 0x20003
    s_lshl_b32 s69, s69, 1
    s_and_b32 s65, s2, 7
    v_and_b32 v1, 63, v0
    v_and_b32 v2, 31, v0
    s_lshl_b32 s88, s69, 12
    v_lshl_add_u32 v3, v0, 4, s88
    s_lshr_b32 s89, s69, 1
    s_lshl_b32 s88, s89, 7
    v_lshl_add_u32 v4, v2, 2, s88
    s_waitcnt lgkmcnt(0)
    s_lshl_b32 s90, s70, 2
    s_add_u32 s90, s90, 10649600
    s_load_dword s77, s[18:19], s90
    s_mov_b32 s32, s18
    s_and_b32 s33, s19, 0xffff
    s_mov_b32 s34, 10649664
    s_mov_b32 s35, 0x00020000
    s_mov_b32 s28, s14
    s_and_b32 s29, s15, 0xffff
    s_mov_b32 s30, 2097152
    s_mov_b32 s31, 0x00020000
    s_lshl_b32 s88, s70, 3
    s_add_u32 s88, s88, s65
    s_lshl_b32 s88, s88, 2
    s_add_u32 s88, s88, s89
    s_lshl_b32 s88, s88, 13
    s_and_b32 s89, s69, 1
    s_lshl_b32 s89, s89, 7
    s_add_u32 s88, s88, s89
    v_lshl_add_u32 v5, v2, 8, s88
    v_lshrrev_b32 v6, 5, v0
    v_lshl_add_u32 v5, v6, 4, v5
    v_mov_b32 v8, 0xff800000
    v_mov_b32 v9, 0
    v_mov_b32 v10, 0
    v_mov_b32 v11, 0
    v_mov_b32 v12, 0
    v_mov_b32 v13, 0
    v_mov_b32 v14, 0
    v_mov_b32 v15, 0
    v_mov_b32 v16, 0
    v_mov_b32 v17, 0
    s_mul_i32 s66, s65, 40
    s_add_u32 s66, s66, s70
    s_waitcnt lgkmcnt(0)
C_group:
    s_mov_b32 s76, 0
    s_ff1_i32_b32 s88, s77
    s_bitset0_b32 s77, s88
    s_add_u32 s88, s88, s66
    s_lshl_b32 s89, s88, 9
    s_add_u32 s89, s89, 10485760
    s_lshl_b32 s88, s88, 15
    buffer_load_dword v20, v4, s[32:35], s89 offen
    buffer_load_dwordx4 v[28:31], v3, s[32:35], s88 offen
    s_add_u32 s76, s76, 1
    s_cmp_eq_u32 s77, 0
    s_cbranch_scc1 C_issued
    s_ff1_i32_b32 s88, s77
    s_bitset0_b32 s77, s88
    s_add_u32 s88, s88, s66
    s_lshl_b32 s89, s88, 9
    s_add_u32 s89, s89, 10485760
    s_lshl_b32 s88, s88, 15
    buffer_load_dword v21, v4, s[32:35], s89 offen
    buffer_load_dwordx4 v[32:35], v3, s[32:35], s88 offen
    s_add_u32 s76, s76, 1
    s_cmp_eq_u32 s77, 0
    s_cbranch_scc1 C_issued
    s_ff1_i32_b32 s88, s77
    s_bitset0_b32 s77, s88
    s_add_u32 s88, s88, s66
    s_lshl_b32 s89, s88, 9
    s_add_u32 s89, s89, 10485760
    s_lshl_b32 s88, s88, 15
    buffer_load_dword v22, v4, s[32:35], s89 offen
    buffer_load_dwordx4 v[36:39], v3, s[32:35], s88 offen
    s_add_u32 s76, s76, 1
    s_cmp_eq_u32 s77, 0
    s_cbranch_scc1 C_issued
    s_ff1_i32_b32 s88, s77
    s_bitset0_b32 s77, s88
    s_add_u32 s88, s88, s66
    s_lshl_b32 s89, s88, 9
    s_add_u32 s89, s89, 10485760
    s_lshl_b32 s88, s88, 15
    buffer_load_dword v23, v4, s[32:35], s89 offen
    buffer_load_dwordx4 v[40:43], v3, s[32:35], s88 offen
    s_add_u32 s76, s76, 1
    s_cmp_eq_u32 s77, 0
    s_cbranch_scc1 C_issued
    s_ff1_i32_b32 s88, s77
    s_bitset0_b32 s77, s88
    s_add_u32 s88, s88, s66
    s_lshl_b32 s89, s88, 9
    s_add_u32 s89, s89, 10485760
    s_lshl_b32 s88, s88, 15
    buffer_load_dword v24, v4, s[32:35], s89 offen
    buffer_load_dwordx4 v[44:47], v3, s[32:35], s88 offen
    s_add_u32 s76, s76, 1
    s_cmp_eq_u32 s77, 0
    s_cbranch_scc1 C_issued
    s_ff1_i32_b32 s88, s77
    s_bitset0_b32 s77, s88
    s_add_u32 s88, s88, s66
    s_lshl_b32 s89, s88, 9
    s_add_u32 s89, s89, 10485760
    s_lshl_b32 s88, s88, 15
    buffer_load_dword v25, v4, s[32:35], s89 offen
    buffer_load_dwordx4 v[48:51], v3, s[32:35], s88 offen
    s_add_u32 s76, s76, 1
    s_cmp_eq_u32 s77, 0
    s_cbranch_scc1 C_issued
    s_ff1_i32_b32 s88, s77
    s_bitset0_b32 s77, s88
    s_add_u32 s88, s88, s66
    s_lshl_b32 s89, s88, 9
    s_add_u32 s89, s89, 10485760
    s_lshl_b32 s88, s88, 15
    buffer_load_dword v26, v4, s[32:35], s89 offen
    buffer_load_dwordx4 v[52:55], v3, s[32:35], s88 offen
    s_add_u32 s76, s76, 1
    s_cmp_eq_u32 s77, 0
    s_cbranch_scc1 C_issued
    s_ff1_i32_b32 s88, s77
    s_bitset0_b32 s77, s88
    s_add_u32 s88, s88, s66
    s_lshl_b32 s89, s88, 9
    s_add_u32 s89, s89, 10485760
    s_lshl_b32 s88, s88, 15
    buffer_load_dword v27, v4, s[32:35], s89 offen
    buffer_load_dwordx4 v[56:59], v3, s[32:35], s88 offen
    s_add_u32 s76, s76, 1
C_issued:
    s_waitcnt vmcnt(0)
    v_max_f32 v6, v8, v20
    v_sub_f32 v7, v8, v6
    v_sub_f32 v18, v20, v6
    v_exp_f32 v7, v7
    v_exp_f32 v18, v18
    v_mov_b32 v8, v6
    v_fma_f32 v9, v9, v7, v18
    v_lshlrev_b32 v6, 16, v28
    v_and_b32 v19, 0xffff0000, v28
    v_mul_f32 v6, v6, v18
    v_mul_f32 v19, v19, v18
    v_fma_f32 v10, v10, v7, v6
    v_fma_f32 v11, v11, v7, v19
    v_lshlrev_b32 v6, 16, v29
    v_and_b32 v19, 0xffff0000, v29
    v_mul_f32 v6, v6, v18
    v_mul_f32 v19, v19, v18
    v_fma_f32 v12, v12, v7, v6
    v_fma_f32 v13, v13, v7, v19
    v_lshlrev_b32 v6, 16, v30
    v_and_b32 v19, 0xffff0000, v30
    v_mul_f32 v6, v6, v18
    v_mul_f32 v19, v19, v18
    v_fma_f32 v14, v14, v7, v6
    v_fma_f32 v15, v15, v7, v19
    v_lshlrev_b32 v6, 16, v31
    v_and_b32 v19, 0xffff0000, v31
    v_mul_f32 v6, v6, v18
    v_mul_f32 v19, v19, v18
    v_fma_f32 v16, v16, v7, v6
    v_fma_f32 v17, v17, v7, v19
    s_cmp_eq_u32 s76, 1
    s_cbranch_scc1 C_acc
    v_max_f32 v6, v8, v21
    v_sub_f32 v7, v8, v6
    v_sub_f32 v18, v21, v6
    v_exp_f32 v7, v7
    v_exp_f32 v18, v18
    v_mov_b32 v8, v6
    v_fma_f32 v9, v9, v7, v18
    v_lshlrev_b32 v6, 16, v32
    v_and_b32 v19, 0xffff0000, v32
    v_mul_f32 v6, v6, v18
    v_mul_f32 v19, v19, v18
    v_fma_f32 v10, v10, v7, v6
    v_fma_f32 v11, v11, v7, v19
    v_lshlrev_b32 v6, 16, v33
    v_and_b32 v19, 0xffff0000, v33
    v_mul_f32 v6, v6, v18
    v_mul_f32 v19, v19, v18
    v_fma_f32 v12, v12, v7, v6
    v_fma_f32 v13, v13, v7, v19
    v_lshlrev_b32 v6, 16, v34
    v_and_b32 v19, 0xffff0000, v34
    v_mul_f32 v6, v6, v18
    v_mul_f32 v19, v19, v18
    v_fma_f32 v14, v14, v7, v6
    v_fma_f32 v15, v15, v7, v19
    v_lshlrev_b32 v6, 16, v35
    v_and_b32 v19, 0xffff0000, v35
    v_mul_f32 v6, v6, v18
    v_mul_f32 v19, v19, v18
    v_fma_f32 v16, v16, v7, v6
    v_fma_f32 v17, v17, v7, v19
    s_cmp_eq_u32 s76, 2
    s_cbranch_scc1 C_acc
    v_max_f32 v6, v8, v22
    v_sub_f32 v7, v8, v6
    v_sub_f32 v18, v22, v6
    v_exp_f32 v7, v7
    v_exp_f32 v18, v18
    v_mov_b32 v8, v6
    v_fma_f32 v9, v9, v7, v18
    v_lshlrev_b32 v6, 16, v36
    v_and_b32 v19, 0xffff0000, v36
    v_mul_f32 v6, v6, v18
    v_mul_f32 v19, v19, v18
    v_fma_f32 v10, v10, v7, v6
    v_fma_f32 v11, v11, v7, v19
    v_lshlrev_b32 v6, 16, v37
    v_and_b32 v19, 0xffff0000, v37
    v_mul_f32 v6, v6, v18
    v_mul_f32 v19, v19, v18
    v_fma_f32 v12, v12, v7, v6
    v_fma_f32 v13, v13, v7, v19
    v_lshlrev_b32 v6, 16, v38
    v_and_b32 v19, 0xffff0000, v38
    v_mul_f32 v6, v6, v18
    v_mul_f32 v19, v19, v18
    v_fma_f32 v14, v14, v7, v6
    v_fma_f32 v15, v15, v7, v19
    v_lshlrev_b32 v6, 16, v39
    v_and_b32 v19, 0xffff0000, v39
    v_mul_f32 v6, v6, v18
    v_mul_f32 v19, v19, v18
    v_fma_f32 v16, v16, v7, v6
    v_fma_f32 v17, v17, v7, v19
    s_cmp_eq_u32 s76, 3
    s_cbranch_scc1 C_acc
    v_max_f32 v6, v8, v23
    v_sub_f32 v7, v8, v6
    v_sub_f32 v18, v23, v6
    v_exp_f32 v7, v7
    v_exp_f32 v18, v18
    v_mov_b32 v8, v6
    v_fma_f32 v9, v9, v7, v18
    v_lshlrev_b32 v6, 16, v40
    v_and_b32 v19, 0xffff0000, v40
    v_mul_f32 v6, v6, v18
    v_mul_f32 v19, v19, v18
    v_fma_f32 v10, v10, v7, v6
    v_fma_f32 v11, v11, v7, v19
    v_lshlrev_b32 v6, 16, v41
    v_and_b32 v19, 0xffff0000, v41
    v_mul_f32 v6, v6, v18
    v_mul_f32 v19, v19, v18
    v_fma_f32 v12, v12, v7, v6
    v_fma_f32 v13, v13, v7, v19
    v_lshlrev_b32 v6, 16, v42
    v_and_b32 v19, 0xffff0000, v42
    v_mul_f32 v6, v6, v18
    v_mul_f32 v19, v19, v18
    v_fma_f32 v14, v14, v7, v6
    v_fma_f32 v15, v15, v7, v19
    v_lshlrev_b32 v6, 16, v43
    v_and_b32 v19, 0xffff0000, v43
    v_mul_f32 v6, v6, v18
    v_mul_f32 v19, v19, v18
    v_fma_f32 v16, v16, v7, v6
    v_fma_f32 v17, v17, v7, v19
    s_cmp_eq_u32 s76, 4
    s_cbranch_scc1 C_acc
    v_max_f32 v6, v8, v24
    v_sub_f32 v7, v8, v6
    v_sub_f32 v18, v24, v6
    v_exp_f32 v7, v7
    v_exp_f32 v18, v18
    v_mov_b32 v8, v6
    v_fma_f32 v9, v9, v7, v18
    v_lshlrev_b32 v6, 16, v44
    v_and_b32 v19, 0xffff0000, v44
    v_mul_f32 v6, v6, v18
    v_mul_f32 v19, v19, v18
    v_fma_f32 v10, v10, v7, v6
    v_fma_f32 v11, v11, v7, v19
    v_lshlrev_b32 v6, 16, v45
    v_and_b32 v19, 0xffff0000, v45
    v_mul_f32 v6, v6, v18
    v_mul_f32 v19, v19, v18
    v_fma_f32 v12, v12, v7, v6
    v_fma_f32 v13, v13, v7, v19
    v_lshlrev_b32 v6, 16, v46
    v_and_b32 v19, 0xffff0000, v46
    v_mul_f32 v6, v6, v18
    v_mul_f32 v19, v19, v18
    v_fma_f32 v14, v14, v7, v6
    v_fma_f32 v15, v15, v7, v19
    v_lshlrev_b32 v6, 16, v47
    v_and_b32 v19, 0xffff0000, v47
    v_mul_f32 v6, v6, v18
    v_mul_f32 v19, v19, v18
    v_fma_f32 v16, v16, v7, v6
    v_fma_f32 v17, v17, v7, v19
    s_cmp_eq_u32 s76, 5
    s_cbranch_scc1 C_acc
    v_max_f32 v6, v8, v25
    v_sub_f32 v7, v8, v6
    v_sub_f32 v18, v25, v6
    v_exp_f32 v7, v7
    v_exp_f32 v18, v18
    v_mov_b32 v8, v6
    v_fma_f32 v9, v9, v7, v18
    v_lshlrev_b32 v6, 16, v48
    v_and_b32 v19, 0xffff0000, v48
    v_mul_f32 v6, v6, v18
    v_mul_f32 v19, v19, v18
    v_fma_f32 v10, v10, v7, v6
    v_fma_f32 v11, v11, v7, v19
    v_lshlrev_b32 v6, 16, v49
    v_and_b32 v19, 0xffff0000, v49
    v_mul_f32 v6, v6, v18
    v_mul_f32 v19, v19, v18
    v_fma_f32 v12, v12, v7, v6
    v_fma_f32 v13, v13, v7, v19
    v_lshlrev_b32 v6, 16, v50
    v_and_b32 v19, 0xffff0000, v50
    v_mul_f32 v6, v6, v18
    v_mul_f32 v19, v19, v18
    v_fma_f32 v14, v14, v7, v6
    v_fma_f32 v15, v15, v7, v19
    v_lshlrev_b32 v6, 16, v51
    v_and_b32 v19, 0xffff0000, v51
    v_mul_f32 v6, v6, v18
    v_mul_f32 v19, v19, v18
    v_fma_f32 v16, v16, v7, v6
    v_fma_f32 v17, v17, v7, v19
    s_cmp_eq_u32 s76, 6
    s_cbranch_scc1 C_acc
    v_max_f32 v6, v8, v26
    v_sub_f32 v7, v8, v6
    v_sub_f32 v18, v26, v6
    v_exp_f32 v7, v7
    v_exp_f32 v18, v18
    v_mov_b32 v8, v6
    v_fma_f32 v9, v9, v7, v18
    v_lshlrev_b32 v6, 16, v52
    v_and_b32 v19, 0xffff0000, v52
    v_mul_f32 v6, v6, v18
    v_mul_f32 v19, v19, v18
    v_fma_f32 v10, v10, v7, v6
    v_fma_f32 v11, v11, v7, v19
    v_lshlrev_b32 v6, 16, v53
    v_and_b32 v19, 0xffff0000, v53
    v_mul_f32 v6, v6, v18
    v_mul_f32 v19, v19, v18
    v_fma_f32 v12, v12, v7, v6
    v_fma_f32 v13, v13, v7, v19
    v_lshlrev_b32 v6, 16, v54
    v_and_b32 v19, 0xffff0000, v54
    v_mul_f32 v6, v6, v18
    v_mul_f32 v19, v19, v18
    v_fma_f32 v14, v14, v7, v6
    v_fma_f32 v15, v15, v7, v19
    v_lshlrev_b32 v6, 16, v55
    v_and_b32 v19, 0xffff0000, v55
    v_mul_f32 v6, v6, v18
    v_mul_f32 v19, v19, v18
    v_fma_f32 v16, v16, v7, v6
    v_fma_f32 v17, v17, v7, v19
    s_cmp_eq_u32 s76, 7
    s_cbranch_scc1 C_acc
    v_max_f32 v6, v8, v27
    v_sub_f32 v7, v8, v6
    v_sub_f32 v18, v27, v6
    v_exp_f32 v7, v7
    v_exp_f32 v18, v18
    v_mov_b32 v8, v6
    v_fma_f32 v9, v9, v7, v18
    v_lshlrev_b32 v6, 16, v56
    v_and_b32 v19, 0xffff0000, v56
    v_mul_f32 v6, v6, v18
    v_mul_f32 v19, v19, v18
    v_fma_f32 v10, v10, v7, v6
    v_fma_f32 v11, v11, v7, v19
    v_lshlrev_b32 v6, 16, v57
    v_and_b32 v19, 0xffff0000, v57
    v_mul_f32 v6, v6, v18
    v_mul_f32 v19, v19, v18
    v_fma_f32 v12, v12, v7, v6
    v_fma_f32 v13, v13, v7, v19
    v_lshlrev_b32 v6, 16, v58
    v_and_b32 v19, 0xffff0000, v58
    v_mul_f32 v6, v6, v18
    v_mul_f32 v19, v19, v18
    v_fma_f32 v14, v14, v7, v6
    v_fma_f32 v15, v15, v7, v19
    v_lshlrev_b32 v6, 16, v59
    v_and_b32 v19, 0xffff0000, v59
    v_mul_f32 v6, v6, v18
    v_mul_f32 v19, v19, v18
    v_fma_f32 v16, v16, v7, v6
    v_fma_f32 v17, v17, v7, v19
C_acc:
    s_cmp_lg_u32 s77, 0
    s_cbranch_scc1 C_group
    v_rcp_f32 v9, v9
    s_nop 0
    v_mul_f32 v10, v10, v9
    v_mul_f32 v11, v11, v9
    v_mul_f32 v12, v12, v9
    v_mul_f32 v13, v13, v9
    v_mul_f32 v14, v14, v9
    v_mul_f32 v15, v15, v9
    v_mul_f32 v16, v16, v9
    v_mul_f32 v17, v17, v9
    v_cvt_pk_bf16_f32 v20, v10, v11
    v_cvt_pk_bf16_f32 v21, v12, v13
    v_cvt_pk_bf16_f32 v22, v14, v15
    v_cvt_pk_bf16_f32 v23, v16, v17
    buffer_store_dwordx4 v[20:23], v5, s[28:31], 0 offen
C_exit:
    s_endpgm
.section .rodata,"a"
.p2align 6
.amdhsa_kernel standalone__paged_block_table_kv_pagedattention__sampling_kernel
  .amdhsa_next_free_vgpr 216
  .amdhsa_next_free_sgpr 102
  .amdhsa_accum_offset 216
  .amdhsa_group_segment_fixed_size 0
  .amdhsa_kernarg_size 64
  .amdhsa_user_sgpr_count 2
  .amdhsa_user_sgpr_kernarg_segment_ptr 1
  .amdhsa_system_sgpr_workgroup_id_x 1
.end_amdhsa_kernel
.section .rodata,"a"
.p2align 6
.amdhsa_kernel combine_kernel
  .amdhsa_next_free_vgpr 64
  .amdhsa_next_free_sgpr 102
  .amdhsa_accum_offset 64
  .amdhsa_group_segment_fixed_size 0
  .amdhsa_kernarg_size 64
  .amdhsa_user_sgpr_count 2
  .amdhsa_user_sgpr_kernarg_segment_ptr 1
  .amdhsa_system_sgpr_workgroup_id_x 1
.end_amdhsa_kernel
```
